```python
import torch

def _softmax(x, axis=-1):
    return torch.softmax(x, dim=axis)

def _gelu(x):
    return torch.nn.functional.gelu(x, approximate='tanh')

def _silu(x):
    return torch.nn.functional.silu(x)

def _sigmoid(x):
    return torch.sigmoid(x)

def _layernorm(x, axis=-1, eps=1e-05):
    m = x.mean(dim=axis, keepdim=True)
    v = x.var(dim=axis, keepdim=True, unbiased=False)
    return (x - m) / torch.sqrt(v + eps)

def _scatter_add(tgt, idx, src, axis=0):
    return tgt.clone().index_add_(axis, idx, src)

def _segment_sum(src, seg, n):
    out = torch.zeros((n,) + src.shape[1:], dtype=src.dtype)
    return out.index_add_(0, seg, src)

def _pad(x, pw):
    flat = tuple((v for pair in reversed(pw) for v in pair))
    return torch.nn.functional.pad(x, flat)
kernel_name = 'adaLN_cond__mha_block_cached__glu_gated_swiglu__decode'

def setup_inputs():

    _w = lambda a: (lambda t: t.to(torch.bfloat16) if t.is_floating_point() else t)(torch.as_tensor(a))

    def _A_setup():
        B, Sq, D = (2, 1, 512)
        H, Sk, Dh = (32, 8192, 128)
        return {'x': _w((lambda *s: torch.randn(*s, dtype=torch.bfloat16) * 0.1)(B, Sq, D)), 'k_cache': _w((lambda *s: torch.randn(*s, dtype=torch.bfloat16) * 0.8)(B, H, Sk, Dh)), 'v_cache': _w((lambda *s: torch.randn(*s, dtype=torch.bfloat16) * 3.2)(B, H, Sk, Dh)), 'wq': _w((lambda *s: torch.randn(*s, dtype=torch.bfloat16) * 0.8)(D, H * Dh) * D ** (-0.5)), 'wo': _w((lambda *s: torch.randn(*s, dtype=torch.bfloat16) * 3.2)(H * Dh, D) * (H * Dh) ** (-0.5))}
    _A_in = _A_setup()

    def _B_setup():
        B, S, D, F = (2, 1, 512, 1376)
        return {'x': _w((lambda *s: torch.randn(*s, dtype=torch.bfloat16) * 0.1)(B, S, D)), 'w1': _w((lambda *s: torch.randn(*s, dtype=torch.bfloat16) * 3.2)(D, F) * (2.0 / D) ** 0.5), 'w3': _w((lambda *s: torch.randn(*s, dtype=torch.bfloat16) * 3.2)(D, F) * (2.0 / D) ** 0.5), 'w2': _w((lambda *s: torch.randn(*s, dtype=torch.bfloat16) * 3.2)(F, D) * (2.0 / F) ** 0.5)}
    _B_in = _B_setup()
    return {'A_x': _A_in['x'], 'A_k_cache': _A_in['k_cache'], 'A_v_cache': _A_in['v_cache'], 'A_wq': _A_in['wq'], 'A_wo': _A_in['wo'], 'B_x': _B_in['x'], 'B_w1': _B_in['w1'], 'B_w3': _B_in['w3'], 'B_w2': _B_in['w2'], 'c': _w((lambda *s: torch.randn(*s, dtype=torch.bfloat16) * 0.2)(2, 512) * 8.0), 'w_mod': _w((lambda *s: torch.randn(*s, dtype=torch.bfloat16) * 0.2)(512, 6 * 512) * 512 ** (-0.5) * 8.0)}

def reference(A_x, A_k_cache, A_v_cache, A_wq, A_wo, B_x, B_w1, B_w3, B_w2, c, w_mod):

    def _A_ref(x, k_cache, v_cache, wq, wo):
        B, Sq, D = x.shape
        H, Dh = (32, 128)
        q = (lambda x, *d: x.permute(*d))((x @ wq).reshape(B, Sq, H, Dh), 0, 2, 1, 3)
        scores = torch.einsum('bhqd,bhkd->bhqk', q, k_cache) * Dh ** (-0.5)
        p = _softmax(scores, axis=-1)
        o = torch.einsum('bhqk,bhkd->bhqd', p, v_cache)
        return (lambda x, *d: x.permute(*d))(o, 0, 2, 1, 3).reshape(B, Sq, H * Dh) @ wo

    def _B_ref(x, w1, w3, w2):
        gate = torch.einsum('bsd,df->bsf', x, w1)
        up = torch.einsum('bsd,df->bsf', x, w3)
        h = _silu(gate) * up
        out = torch.einsum('bsf,fd->bsd', h, w2)
        return out
    x = A_x
    mod = (_silu(c) @ w_mod).reshape(c.shape[0], 6, 1, -1)
    sa, ca, ga, sb, cb, gb = (mod[:, 0].clone(), mod[:, 1].clone(), mod[:, 2].clone(), mod[:, 3].clone(), mod[:, 4].clone(), mod[:, 5].clone())
    h = _layernorm(x, axis=-1) * (1 + ca) + sa
    x = x + ga * _A_ref(h, A_k_cache, A_v_cache, A_wq, A_wo)
    h = _layernorm(x, axis=-1) * (1 + cb) + sb
    x = x + gb * _B_ref(h, B_w1, B_w3, B_w2)
    return x
```

```asm
; @launch grid=(256,1,1) block=(512,1,1) lds=152800
.amdgcn_target "amdgcn-amd-amdhsa--gfx950"
.text
.globl adaLN_cond__mha_block_cached__glu_gated_swiglu__decode_kernel
.p2align 8
.type adaLN_cond__mha_block_cached__glu_gated_swiglu__decode_kernel,@function
adaLN_cond__mha_block_cached__glu_gated_swiglu__decode_kernel:
    s_cmp_ge_u32 s2, 256
    s_cbranch_scc1 L_bail
    s_load_dwordx16 s[16:31], s[0:1], 0
    s_load_dwordx8 s[32:39], s[0:1], 64
    s_load_dwordx4 s[40:43], s[0:1], 96
    v_and_b32 v1, 63, v0
    v_lshrrev_b32 v2, 6, v0
    s_nop 0
    v_readfirstlane_b32 s3, v2
    s_mov_b32 s98, 1048576
    s_mov_b32 s99, 0
    s_and_b32 s4, s2, 7
    s_lshr_b32 s5, s2, 3
    s_lshr_b32 s8, s2, 7
    s_lshr_b32 s6, s2, 4
    s_and_b32 s6, s6, 7
    s_lshl_b32 s6, s6, 2
    s_bfe_u32 s7, s2, 0x20001
    s_add_u32 s6, s6, s7
    s_and_b32 s9, s5, 1
    s_lshl_b32 s9, s9, 1
    s_and_b32 s7, s2, 1
    s_add_u32 s9, s9, s7
    s_lshl_b32 s7, s8, 2
    s_add_u32 s7, s7, s9
    v_and_b32 v2, 15, v1
    v_lshrrev_b32 v3, 4, v1
    v_bfe_u32 v4, v1, 2, 2
    v_and_b32 v5, 3, v1
    s_cmp_ge_u32 s3, 4
    s_cbranch_scc1 L_service
    s_lshl_b32 s12, s3, 12
    v_lshlrev_b32 v6, 8, v4
    v_lshl_add_u32 v6, v3, 6, v6
    v_lshl_add_u32 v6, v5, 4, v6
    v_add_u32 v6, s12, v6
    v_lshlrev_b32 v7, 4, v1
    v_add_u32 v7, s12, v7
    s_lshl_b32 s13, s2, 19
    s_and_b32 s13, s13, 0xff800000
    s_lshl_b32 s14, s6, 21
    s_and_b32 s14, s14, 0x600000
    s_add_u32 s13, s13, s14
    s_lshr_b32 s12, s4, 1
    s_mul_i32 s12, s12, 11
    s_lshr_b32 s15, s2, 4
    s_add_u32 s12, s12, s15
    s_max_u32 s15, s15, 10
    s_add_u32 s12, s12, s15
    s_mov_b32 s14, 0x800000
    s_mov_b32 s15, 0x1800100
    s_mov_b32 s75, 0x80808080
    s_lshr_b32 s64, s2, 4
    s_cmp_lt_u32 s64, 11
    s_cselect_b32 s12, s12, 99
    s_cmp_lt_u32 s12, 53
    s_cselect_b32 s14, 0x780000, s14
    s_cselect_b32 s15, 0x17c00fc, s15
    s_cselect_b32 s75, 0x84808478, s75
    s_lshl_b32 s12, s9, 4
    s_lshr_b64 s[14:15], s[14:15], s12
    s_and_b32 s14, s14, 0xffff
    s_lshl_b32 s14, s14, 12
    s_add_u32 s13, s13, s14
    s_lshl_b32 s12, s9, 3
    s_lshr_b32 s75, s75, s12
    s_and_b32 s75, s75, 0xff
    s_lshl_b32 s74, s75, 12
    s_mov_b32 s64, 0
    s_mov_b32 s65, 0
    s_waitcnt lgkmcnt(0)
    s_add_u32 s44, s18, s13
    s_addc_u32 s45, s19, 0
    s_mov_b32 s46, s74
    s_mov_b32 s47, 0x20000
    s_add_u32 s48, s20, s13
    s_addc_u32 s49, s21, 0
    s_mov_b32 s50, s74
    s_mov_b32 s51, 0x20000
    buffer_load_dwordx4 v[64:67], v6, s[44:47], s64 offen offset:0 nt
    buffer_load_dwordx4 v[68:71], v6, s[44:47], s64 offen offset:1024 nt
    buffer_load_dwordx4 v[72:75], v6, s[44:47], s64 offen offset:2048 nt
    buffer_load_dwordx4 v[76:79], v6, s[44:47], s64 offen offset:3072 nt
    s_addk_i32 s64, 0x4000
    buffer_load_dwordx4 v[80:83], v6, s[44:47], s64 offen offset:0 nt
    s_load_dword s11, s[42:43], 0
    v_and_b32 v28, 1, v1
    v_cmp_eq_u32 vcc, 1, v28
    v_mov_b32 v29, 0xffff
    v_mov_b32 v30, 0xffff0000
    v_cndmask_b32 v29, v29, v30, vcc
    v_lshrrev_b32 v28, 1, v2
    v_cmp_eq_u32 vcc, 0, v28
    s_nop 1
    v_cndmask_b32 v24, 0, v29, vcc
    v_cmp_eq_u32 vcc, 1, v28
    s_nop 1
    v_cndmask_b32 v25, 0, v29, vcc
    v_cmp_eq_u32 vcc, 2, v28
    s_nop 1
    v_cndmask_b32 v26, 0, v29, vcc
    v_cmp_eq_u32 vcc, 3, v28
    s_nop 1
    v_cndmask_b32 v27, 0, v29, vcc
    s_mov_b32 s52, s42
    s_mov_b32 s53, s43
    s_mov_b32 s54, 0x188000
    s_mov_b32 s55, 0x20000
    s_lshr_b32 s12, s2, 4
    s_lshl_b32 s77, s4, 3
    s_and_b32 s13, s12, 7
    s_add_u32 s77, s77, s13
    s_mov_b32 s72, s77
    s_lshr_b32 s76, s12, 3
    s_lshl_b32 s76, s76, 2
    s_cmp_ge_u32 s9, 2
    s_cbranch_scc1 L_role_1
    s_lshl_b32 s72, s4, 4
    s_add_u32 s72, s72, s12
    s_add_u32 s72, s72, 64
    s_lshr_b32 s77, s4, 1
    s_mul_i32 s77, s77, 11
    s_add_u32 s77, s77, s12
    s_cmp_lt_u32 s77, 43
    s_cselect_b32 s76, 1, 0
    s_cmp_lt_u32 s12, 11
    s_cselect_b32 s76, s76, 0
    s_cmp_eq_u32 s9, 0
    s_cselect_b32 s76, s76, 0
L_role_1:
    v_lshrrev_b32 v37, 2, v2
    v_lshlrev_b32 v36, 6, v3
    v_lshl_add_u32 v36, v37, 4, v36
    v_add_u32 v36, 148224, v36
    s_mul_i32 s73, s3, 28672
    s_add_u32 s73, s73, 32768
    v_lshlrev_b32 v38, 4, v1
    v_add_u32 v38, s73, v38
    s_sub_u32 s75, s75, s3
    s_add_u32 s75, s75, 3
    s_lshr_b32 s75, s75, 2
    v_mov_b32 v48, 0xff800000
    v_mov_b32 v47, 0xff800000
    s_waitcnt vmcnt(4)
    buffer_load_dwordx4 v[84:87], v6, s[44:47], s64 offen offset:1024 nt
    s_waitcnt vmcnt(4)
    buffer_load_dwordx4 v[88:91], v6, s[44:47], s64 offen offset:2048 nt
    s_waitcnt vmcnt(4)
    buffer_load_dwordx4 v[92:95], v6, s[44:47], s64 offen offset:3072 nt
    s_addk_i32 s64, 0x4000
    s_waitcnt vmcnt(4)
    buffer_load_dwordx4 v[96:99], v6, s[44:47], s64 offen offset:0 nt
    s_waitcnt vmcnt(4)
    buffer_load_dwordx4 v[100:103], v6, s[44:47], s64 offen offset:1024 nt
    s_waitcnt vmcnt(4)
    buffer_load_dwordx4 v[104:107], v6, s[44:47], s64 offen offset:2048 nt
    s_waitcnt vmcnt(4)
    buffer_load_dwordx4 v[108:111], v6, s[44:47], s64 offen offset:3072 nt
    s_addk_i32 s64, 0x4000
    s_waitcnt vmcnt(4)
    buffer_load_dwordx4 v[112:115], v6, s[44:47], s64 offen offset:0 nt
    s_waitcnt vmcnt(4)
    buffer_load_dwordx4 v[116:119], v6, s[44:47], s64 offen offset:1024 nt
    s_waitcnt vmcnt(4)
    buffer_load_dwordx4 v[120:123], v6, s[44:47], s64 offen offset:2048 nt
    s_waitcnt vmcnt(4)
    buffer_load_dwordx4 v[124:127], v6, s[44:47], s64 offen offset:3072 nt
    s_addk_i32 s64, 0x4000
    s_waitcnt vmcnt(4)
    buffer_load_dwordx4 v[128:131], v6, s[44:47], s64 offen offset:0 nt
    s_waitcnt vmcnt(4)
    buffer_load_dwordx4 v[132:135], v6, s[44:47], s64 offen offset:1024 nt
    s_waitcnt vmcnt(4)
    buffer_load_dwordx4 v[136:139], v6, s[44:47], s64 offen offset:2048 nt
    s_waitcnt vmcnt(4)
    buffer_load_dwordx4 v[140:143], v6, s[44:47], s64 offen offset:3072 nt
    s_addk_i32 s64, 0x4000
    s_waitcnt vmcnt(4)
    buffer_load_dwordx4 v[144:147], v6, s[44:47], s64 offen offset:0 nt
    s_waitcnt vmcnt(4)
    buffer_load_dwordx4 v[148:151], v6, s[44:47], s64 offen offset:1024 nt
    s_waitcnt vmcnt(4)
    buffer_load_dwordx4 v[152:155], v6, s[44:47], s64 offen offset:2048 nt
    s_waitcnt vmcnt(4)
    buffer_load_dwordx4 v[156:159], v6, s[44:47], s64 offen offset:3072 nt
    s_addk_i32 s64, 0x4000
    s_waitcnt vmcnt(4)
    buffer_load_dwordx4 v[160:163], v6, s[44:47], s64 offen offset:0 nt
    s_waitcnt vmcnt(4)
    buffer_load_dwordx4 v[164:167], v6, s[44:47], s64 offen offset:1024 nt
    s_waitcnt vmcnt(4)
    buffer_load_dwordx4 v[168:171], v6, s[44:47], s64 offen offset:2048 nt
    s_waitcnt vmcnt(4)
    buffer_load_dwordx4 v[172:175], v6, s[44:47], s64 offen offset:3072 nt
    s_addk_i32 s64, 0x4000
    s_waitcnt vmcnt(4)
    buffer_load_dwordx4 v[176:179], v6, s[44:47], s64 offen offset:0 nt
    s_waitcnt vmcnt(4)
    buffer_load_dwordx4 v[180:183], v6, s[44:47], s64 offen offset:1024 nt
    s_waitcnt vmcnt(4)
    buffer_load_dwordx4 v[184:187], v6, s[44:47], s64 offen offset:2048 nt
    s_waitcnt vmcnt(4)
    buffer_load_dwordx4 v[188:191], v6, s[44:47], s64 offen offset:3072 nt
    s_addk_i32 s64, 0x4000
    s_waitcnt vmcnt(4)
    buffer_load_dwordx4 v[192:195], v6, s[44:47], s64 offen offset:0 nt
    s_waitcnt vmcnt(4)
    buffer_load_dwordx4 v[196:199], v6, s[44:47], s64 offen offset:1024 nt
    s_waitcnt vmcnt(4)
    buffer_load_dwordx4 v[200:203], v6, s[44:47], s64 offen offset:2048 nt
    s_waitcnt vmcnt(4)
    buffer_load_dwordx4 v[204:207], v6, s[44:47], s64 offen offset:3072 nt
    s_addk_i32 s64, 0x4000
    s_waitcnt vmcnt(4)
    buffer_load_dwordx4 v[208:211], v6, s[44:47], s64 offen offset:0 nt
    s_waitcnt vmcnt(4)
    buffer_load_dwordx4 v[212:215], v6, s[44:47], s64 offen offset:1024 nt
    s_waitcnt vmcnt(4)
    buffer_load_dwordx4 v[216:219], v6, s[44:47], s64 offen offset:2048 nt
    s_waitcnt vmcnt(4)
    buffer_load_dwordx4 v[220:223], v6, s[44:47], s64 offen offset:3072 nt
    s_addk_i32 s64, 0x4000
    s_waitcnt vmcnt(4)
    buffer_load_dwordx4 v[224:227], v6, s[44:47], s64 offen offset:0 nt
    s_waitcnt vmcnt(4)
    buffer_load_dwordx4 v[228:231], v6, s[44:47], s64 offen offset:1024 nt
    s_waitcnt vmcnt(4)
    buffer_load_dwordx4 v[232:235], v6, s[44:47], s64 offen offset:2048 nt
    s_waitcnt vmcnt(4)
    buffer_load_dwordx4 v[236:239], v6, s[44:47], s64 offen offset:3072 nt
    s_addk_i32 s64, 0x4000
    s_waitcnt vmcnt(4)
    buffer_load_dwordx4 v[240:243], v6, s[44:47], s64 offen offset:0 nt
    s_waitcnt vmcnt(4)
    buffer_load_dwordx4 v[244:247], v6, s[44:47], s64 offen offset:1024 nt
    s_waitcnt vmcnt(4)
    buffer_load_dwordx4 v[248:251], v6, s[44:47], s64 offen offset:2048 nt
    s_waitcnt vmcnt(4)
    buffer_load_dwordx4 v[252:255], v6, s[44:47], s64 offen offset:3072 nt
    s_addk_i32 s64, 0x4000
    s_mov_b32 m0, s73
    s_mov_b32 s12, 6
L_dma:
    s_waitcnt vmcnt(4)
    buffer_load_dwordx4 v6, s[44:47], s64 offen offset:0 nt lds
    s_waitcnt vmcnt(4)
    buffer_load_dwordx4 v6, s[44:47], s64 offen offset:1024 nt lds
    s_waitcnt vmcnt(4)
    buffer_load_dwordx4 v6, s[44:47], s64 offen offset:2048 nt lds
    s_waitcnt vmcnt(4)
    buffer_load_dwordx4 v6, s[44:47], s64 offen offset:3072 nt lds
    s_addk_i32 s64, 0x4000
    s_add_u32 m0, m0, 0x1000
    s_sub_u32 s12, s12, 1
    s_cbranch_scc0 L_dma
    s_waitcnt lgkmcnt(0)
    s_add_u32 s10, s11, 0x9e3779b9
    s_barrier
    ds_read_b128 v[28:31], v36
    s_waitcnt lgkmcnt(0)
    v_cmp_eq_u32 vcc, 0, v5
    s_nop 1
    v_cndmask_b32 v8, 0, v28, vcc
    v_cndmask_b32 v9, 0, v29, vcc
    v_cndmask_b32 v10, 0, v30, vcc
    v_cndmask_b32 v11, 0, v31, vcc
    v_cmp_eq_u32 vcc, 1, v5
    s_nop 1
    v_cndmask_b32 v12, 0, v28, vcc
    v_cndmask_b32 v13, 0, v29, vcc
    v_cndmask_b32 v14, 0, v30, vcc
    v_cndmask_b32 v15, 0, v31, vcc
    v_cmp_eq_u32 vcc, 2, v5
    s_nop 1
    v_cndmask_b32 v16, 0, v28, vcc
    v_cndmask_b32 v17, 0, v29, vcc
    v_cndmask_b32 v18, 0, v30, vcc
    v_cndmask_b32 v19, 0, v31, vcc
    v_cmp_eq_u32 vcc, 3, v5
    s_nop 1
    v_cndmask_b32 v20, 0, v28, vcc
    v_cndmask_b32 v21, 0, v29, vcc
    v_cndmask_b32 v22, 0, v30, vcc
    v_cndmask_b32 v23, 0, v31, vcc
    v_mfma_f32_16x16x32_bf16 v[28:31], v[64:67], v[8:11], 0
    v_mfma_f32_16x16x32_bf16 v[28:31], v[68:71], v[12:15], v[28:31]
    ds_read_b128 v[64:67], v38 offset:0
    v_mfma_f32_16x16x32_bf16 v[28:31], v[72:75], v[16:19], v[28:31]
    s_waitcnt vmcnt(4)
    buffer_load_dwordx4 v[72:75], v6, s[44:47], s64 offen offset:0 nt
    v_mfma_f32_16x16x32_bf16 v[28:31], v[76:79], v[20:23], v[28:31]
    ds_read_b128 v[68:71], v38 offset:1024
    v_mfma_f32_16x16x32_bf16 v[32:35], v[80:83], v[8:11], 0
    ds_read_b128 v[76:79], v38 offset:2048
    v_mfma_f32_16x16x32_bf16 v[32:35], v[84:87], v[12:15], v[32:35]
    s_waitcnt vmcnt(4)
    buffer_load_dwordx4 v[84:87], v6, s[44:47], s64 offen offset:1024 nt
    v_mfma_f32_16x16x32_bf16 v[32:35], v[88:91], v[16:19], v[32:35]
    s_nop 0
    v_mov_b32_dpp v40, v28 quad_perm:[0,1,2,3] row_mask:0xf bank_mask:0x1
    ds_read_b128 v[80:83], v38 offset:3072
    s_nop 0
    v_add_f32_dpp v40, v29, v40 row_ror:12 row_mask:0xf bank_mask:0x1
    v_mfma_f32_16x16x32_bf16 v[32:35], v[92:95], v[20:23], v[32:35]
    s_nop 0
    v_add_f32_dpp v40, v30, v40 row_ror:8 row_mask:0xf bank_mask:0x1
    ds_read_b128 v[88:91], v38 offset:4096
    s_nop 0
    v_add_f32_dpp v40, v31, v40 row_ror:4 row_mask:0xf bank_mask:0x1
    v_mfma_f32_16x16x32_bf16 v[28:31], v[96:99], v[8:11], 0
    s_waitcnt vmcnt(4)
    buffer_load_dwordx4 v[96:99], v6, s[44:47], s64 offen offset:2048 nt
    v_mfma_f32_16x16x32_bf16 v[28:31], v[100:103], v[12:15], v[28:31]
    ds_read_b128 v[92:95], v38 offset:5120
    v_mfma_f32_16x16x32_bf16 v[28:31], v[104:107], v[16:19], v[28:31]
    v_mov_b32_dpp v40, v33 quad_perm:[0,1,2,3] row_mask:0xf bank_mask:0x2
    ds_read_b128 v[100:103], v38 offset:6144
    s_nop 0
    v_add_f32_dpp v40, v32, v40 row_ror:4 row_mask:0xf bank_mask:0x2
    v_mfma_f32_16x16x32_bf16 v[28:31], v[108:111], v[20:23], v[28:31]
    s_nop 0
    v_add_f32_dpp v40, v34, v40 row_ror:12 row_mask:0xf bank_mask:0x2
    s_waitcnt vmcnt(4)
    buffer_load_dwordx4 v[108:111], v6, s[44:47], s64 offen offset:3072 nt
    s_addk_i32 s64, 0x4000
    v_add_f32_dpp v40, v35, v40 row_ror:8 row_mask:0xf bank_mask:0x2
    v_mfma_f32_16x16x32_bf16 v[32:35], v[112:115], v[8:11], 0
    ds_read_b128 v[104:107], v38 offset:7168
    v_mfma_f32_16x16x32_bf16 v[32:35], v[116:119], v[12:15], v[32:35]
    ds_read_b128 v[112:115], v38 offset:8192
    v_mfma_f32_16x16x32_bf16 v[32:35], v[120:123], v[16:19], v[32:35]
    v_mov_b32_dpp v40, v30 quad_perm:[0,1,2,3] row_mask:0xf bank_mask:0x4
    s_waitcnt vmcnt(4)
    buffer_load_dwordx4 v[120:123], v6, s[44:47], s64 offen offset:0 nt
    v_add_f32_dpp v40, v28, v40 row_ror:8 row_mask:0xf bank_mask:0x4
    v_mfma_f32_16x16x32_bf16 v[32:35], v[124:127], v[20:23], v[32:35]
    s_nop 0
    v_add_f32_dpp v40, v29, v40 row_ror:4 row_mask:0xf bank_mask:0x4
    ds_read_b128 v[116:119], v38 offset:9216
    s_nop 0
    v_add_f32_dpp v40, v31, v40 row_ror:12 row_mask:0xf bank_mask:0x4
    v_mfma_f32_16x16x32_bf16 v[28:31], v[128:131], v[8:11], 0
    ds_read_b128 v[124:127], v38 offset:10240
    v_mfma_f32_16x16x32_bf16 v[28:31], v[132:135], v[12:15], v[28:31]
    s_waitcnt vmcnt(4)
    buffer_load_dwordx4 v[132:135], v6, s[44:47], s64 offen offset:1024 nt
    v_mfma_f32_16x16x32_bf16 v[28:31], v[136:139], v[16:19], v[28:31]
    v_mov_b32_dpp v40, v35 quad_perm:[0,1,2,3] row_mask:0xf bank_mask:0x8
    ds_read_b128 v[128:131], v38 offset:11264
    s_nop 0
    v_add_f32_dpp v40, v32, v40 row_ror:12 row_mask:0xf bank_mask:0x8
    v_mfma_f32_16x16x32_bf16 v[28:31], v[140:143], v[20:23], v[28:31]
    s_nop 0
    v_add_f32_dpp v40, v33, v40 row_ror:8 row_mask:0xf bank_mask:0x8
    ds_read_b128 v[136:139], v38 offset:12288
    s_nop 0
    v_add_f32_dpp v40, v34, v40 row_ror:4 row_mask:0xf bank_mask:0x8
    v_mfma_f32_16x16x32_bf16 v[32:35], v[144:147], v[8:11], 0
    s_waitcnt vmcnt(4)
    buffer_load_dwordx4 v[144:147], v6, s[44:47], s64 offen offset:2048 nt
    v_mfma_f32_16x16x32_bf16 v[32:35], v[148:151], v[12:15], v[32:35]
    ds_read_b128 v[140:143], v38 offset:13312
    v_mfma_f32_16x16x32_bf16 v[32:35], v[152:155], v[16:19], v[32:35]
    v_mov_b32_dpp v41, v28 quad_perm:[0,1,2,3] row_mask:0xf bank_mask:0x1
    ds_read_b128 v[148:151], v38 offset:14336
    s_nop 0
    v_add_f32_dpp v41, v29, v41 row_ror:12 row_mask:0xf bank_mask:0x1
    v_mfma_f32_16x16x32_bf16 v[32:35], v[156:159], v[20:23], v[32:35]
    s_nop 0
    v_add_f32_dpp v41, v30, v41 row_ror:8 row_mask:0xf bank_mask:0x1
    s_waitcnt vmcnt(4)
    buffer_load_dwordx4 v[156:159], v6, s[44:47], s64 offen offset:3072 nt
    s_addk_i32 s64, 0x4000
    v_add_f32_dpp v41, v31, v41 row_ror:4 row_mask:0xf bank_mask:0x1
    v_mfma_f32_16x16x32_bf16 v[28:31], v[160:163], v[8:11], 0
    ds_read_b128 v[152:155], v38 offset:15360
    v_mfma_f32_16x16x32_bf16 v[28:31], v[164:167], v[12:15], v[28:31]
    ds_read_b128 v[160:163], v38 offset:16384
    v_mfma_f32_16x16x32_bf16 v[28:31], v[168:171], v[16:19], v[28:31]
    v_mov_b32_dpp v41, v33 quad_perm:[0,1,2,3] row_mask:0xf bank_mask:0x2
    s_waitcnt vmcnt(4)
    buffer_load_dwordx4 v[168:171], v6, s[44:47], s64 offen offset:0 nt
    v_add_f32_dpp v41, v32, v41 row_ror:4 row_mask:0xf bank_mask:0x2
    v_mfma_f32_16x16x32_bf16 v[28:31], v[172:175], v[20:23], v[28:31]
    s_nop 0
    v_add_f32_dpp v41, v34, v41 row_ror:12 row_mask:0xf bank_mask:0x2
    ds_read_b128 v[164:167], v38 offset:17408
    s_nop 0
    v_add_f32_dpp v41, v35, v41 row_ror:8 row_mask:0xf bank_mask:0x2
    v_mfma_f32_16x16x32_bf16 v[32:35], v[176:179], v[8:11], 0
    ds_read_b128 v[172:175], v38 offset:18432
    v_mfma_f32_16x16x32_bf16 v[32:35], v[180:183], v[12:15], v[32:35]
    s_waitcnt vmcnt(4)
    buffer_load_dwordx4 v[180:183], v6, s[44:47], s64 offen offset:1024 nt
    v_mfma_f32_16x16x32_bf16 v[32:35], v[184:187], v[16:19], v[32:35]
    v_mov_b32_dpp v41, v30 quad_perm:[0,1,2,3] row_mask:0xf bank_mask:0x4
    ds_read_b128 v[176:179], v38 offset:19456
    s_nop 0
    v_add_f32_dpp v41, v28, v41 row_ror:8 row_mask:0xf bank_mask:0x4
    v_mfma_f32_16x16x32_bf16 v[32:35], v[188:191], v[20:23], v[32:35]
    s_nop 0
    v_add_f32_dpp v41, v29, v41 row_ror:4 row_mask:0xf bank_mask:0x4
    ds_read_b128 v[184:187], v38 offset:20480
    s_nop 0
    v_add_f32_dpp v41, v31, v41 row_ror:12 row_mask:0xf bank_mask:0x4
    v_mfma_f32_16x16x32_bf16 v[28:31], v[192:195], v[8:11], 0
    s_waitcnt vmcnt(4)
    buffer_load_dwordx4 v[192:195], v6, s[44:47], s64 offen offset:2048 nt
    v_mfma_f32_16x16x32_bf16 v[28:31], v[196:199], v[12:15], v[28:31]
    ds_read_b128 v[188:191], v38 offset:21504
    v_mfma_f32_16x16x32_bf16 v[28:31], v[200:203], v[16:19], v[28:31]
    v_mov_b32_dpp v41, v35 quad_perm:[0,1,2,3] row_mask:0xf bank_mask:0x8
    ds_read_b128 v[196:199], v38 offset:22528
    s_nop 0
    v_add_f32_dpp v41, v32, v41 row_ror:12 row_mask:0xf bank_mask:0x8
    v_mfma_f32_16x16x32_bf16 v[28:31], v[204:207], v[20:23], v[28:31]
    s_nop 0
    v_add_f32_dpp v41, v33, v41 row_ror:8 row_mask:0xf bank_mask:0x8
    s_waitcnt vmcnt(4)
    buffer_load_dwordx4 v[204:207], v6, s[44:47], s64 offen offset:3072 nt
    s_addk_i32 s64, 0x4000
    v_add_f32_dpp v41, v34, v41 row_ror:4 row_mask:0xf bank_mask:0x8
    v_mfma_f32_16x16x32_bf16 v[32:35], v[208:211], v[8:11], 0
    ds_read_b128 v[200:203], v38 offset:23552
    v_mfma_f32_16x16x32_bf16 v[32:35], v[212:215], v[12:15], v[32:35]
    ds_read_b128 v[208:211], v38 offset:24576
    v_mfma_f32_16x16x32_bf16 v[32:35], v[216:219], v[16:19], v[32:35]
    v_mov_b32_dpp v42, v28 quad_perm:[0,1,2,3] row_mask:0xf bank_mask:0x1
    s_waitcnt vmcnt(4)
    buffer_load_dwordx4 v[216:219], v6, s[44:47], s64 offen offset:0 nt
    v_add_f32_dpp v42, v29, v42 row_ror:12 row_mask:0xf bank_mask:0x1
    v_mfma_f32_16x16x32_bf16 v[32:35], v[220:223], v[20:23], v[32:35]
    s_nop 0
    v_add_f32_dpp v42, v30, v42 row_ror:8 row_mask:0xf bank_mask:0x1
    ds_read_b128 v[212:215], v38 offset:25600
    s_nop 0
    v_add_f32_dpp v42, v31, v42 row_ror:4 row_mask:0xf bank_mask:0x1
    v_mfma_f32_16x16x32_bf16 v[28:31], v[224:227], v[8:11], 0
    ds_read_b128 v[220:223], v38 offset:26624
    v_mfma_f32_16x16x32_bf16 v[28:31], v[228:231], v[12:15], v[28:31]
    s_waitcnt vmcnt(4)
    buffer_load_dwordx4 v[228:231], v6, s[44:47], s64 offen offset:1024 nt
    v_mfma_f32_16x16x32_bf16 v[28:31], v[232:235], v[16:19], v[28:31]
    v_mov_b32_dpp v42, v33 quad_perm:[0,1,2,3] row_mask:0xf bank_mask:0x2
    ds_read_b128 v[224:227], v38 offset:27648
    s_nop 0
    v_add_f32_dpp v42, v32, v42 row_ror:4 row_mask:0xf bank_mask:0x2
    v_mfma_f32_16x16x32_bf16 v[28:31], v[236:239], v[20:23], v[28:31]
    s_nop 0
    v_add_f32_dpp v42, v34, v42 row_ror:12 row_mask:0xf bank_mask:0x2
    s_nop 1
    v_add_f32_dpp v42, v35, v42 row_ror:8 row_mask:0xf bank_mask:0x2
    v_mfma_f32_16x16x32_bf16 v[32:35], v[240:243], v[8:11], 0
    s_waitcnt vmcnt(4)
    buffer_load_dwordx4 v[240:243], v6, s[44:47], s64 offen offset:2048 nt
    v_mfma_f32_16x16x32_bf16 v[32:35], v[244:247], v[12:15], v[32:35]
    v_mfma_f32_16x16x32_bf16 v[32:35], v[248:251], v[16:19], v[32:35]
    v_mov_b32_dpp v42, v30 quad_perm:[0,1,2,3] row_mask:0xf bank_mask:0x4
    s_nop 1
    v_add_f32_dpp v42, v28, v42 row_ror:8 row_mask:0xf bank_mask:0x4
    v_mfma_f32_16x16x32_bf16 v[32:35], v[252:255], v[20:23], v[32:35]
    s_nop 0
    v_add_f32_dpp v42, v29, v42 row_ror:4 row_mask:0xf bank_mask:0x4
    s_waitcnt vmcnt(4)
    buffer_load_dwordx4 v[252:255], v6, s[44:47], s64 offen offset:3072 nt
    s_addk_i32 s64, 0x4000
    v_add_f32_dpp v42, v31, v42 row_ror:12 row_mask:0xf bank_mask:0x4
    s_waitcnt lgkmcnt(0)
    s_barrier
    v_mfma_f32_16x16x32_bf16 v[28:31], v[64:67], v[8:11], 0
    v_mfma_f32_16x16x32_bf16 v[28:31], v[68:71], v[12:15], v[28:31]
    v_mfma_f32_16x16x32_bf16 v[28:31], v[76:79], v[16:19], v[28:31]
    v_mov_b32_dpp v42, v35 quad_perm:[0,1,2,3] row_mask:0xf bank_mask:0x8
    s_waitcnt vmcnt(4)
    buffer_load_dwordx4 v[76:79], v6, s[44:47], s64 offen offset:0 nt
    v_add_f32_dpp v42, v32, v42 row_ror:12 row_mask:0xf bank_mask:0x8
    v_mfma_f32_16x16x32_bf16 v[28:31], v[80:83], v[20:23], v[28:31]
    s_nop 0
    v_add_f32_dpp v42, v33, v42 row_ror:8 row_mask:0xf bank_mask:0x8
    s_nop 1
    v_add_f32_dpp v42, v34, v42 row_ror:4 row_mask:0xf bank_mask:0x8
    v_mfma_f32_16x16x32_bf16 v[32:35], v[88:91], v[8:11], 0
    v_mfma_f32_16x16x32_bf16 v[32:35], v[92:95], v[12:15], v[32:35]
    s_waitcnt vmcnt(4)
    buffer_load_dwordx4 v[92:95], v6, s[44:47], s64 offen offset:1024 nt
    v_mfma_f32_16x16x32_bf16 v[32:35], v[100:103], v[16:19], v[32:35]
    v_mov_b32_dpp v43, v28 quad_perm:[0,1,2,3] row_mask:0xf bank_mask:0x1
    s_nop 1
    v_add_f32_dpp v43, v29, v43 row_ror:12 row_mask:0xf bank_mask:0x1
    v_mfma_f32_16x16x32_bf16 v[32:35], v[104:107], v[20:23], v[32:35]
    s_nop 0
    v_add_f32_dpp v43, v30, v43 row_ror:8 row_mask:0xf bank_mask:0x1
    s_nop 1
    v_add_f32_dpp v43, v31, v43 row_ror:4 row_mask:0xf bank_mask:0x1
    v_mfma_f32_16x16x32_bf16 v[28:31], v[112:115], v[8:11], 0
    s_waitcnt vmcnt(4)
    buffer_load_dwordx4 v[112:115], v6, s[44:47], s64 offen offset:2048 nt
    v_mfma_f32_16x16x32_bf16 v[28:31], v[116:119], v[12:15], v[28:31]
    v_mfma_f32_16x16x32_bf16 v[28:31], v[124:127], v[16:19], v[28:31]
    v_mov_b32_dpp v43, v33 quad_perm:[0,1,2,3] row_mask:0xf bank_mask:0x2
    s_nop 1
    v_add_f32_dpp v43, v32, v43 row_ror:4 row_mask:0xf bank_mask:0x2
    v_mfma_f32_16x16x32_bf16 v[28:31], v[128:131], v[20:23], v[28:31]
    s_nop 0
    v_add_f32_dpp v43, v34, v43 row_ror:12 row_mask:0xf bank_mask:0x2
    s_waitcnt vmcnt(4)
    buffer_load_dwordx4 v[128:131], v6, s[44:47], s64 offen offset:3072 nt
    s_addk_i32 s64, 0x4000
    v_add_f32_dpp v43, v35, v43 row_ror:8 row_mask:0xf bank_mask:0x2
    v_mfma_f32_16x16x32_bf16 v[32:35], v[136:139], v[8:11], 0
    v_mfma_f32_16x16x32_bf16 v[32:35], v[140:143], v[12:15], v[32:35]
    v_mfma_f32_16x16x32_bf16 v[32:35], v[148:151], v[16:19], v[32:35]
    v_mov_b32_dpp v43, v30 quad_perm:[0,1,2,3] row_mask:0xf bank_mask:0x4
    s_waitcnt vmcnt(4)
    buffer_load_dwordx4 v[148:151], v6, s[44:47], s64 offen offset:0 nt
    v_add_f32_dpp v43, v28, v43 row_ror:8 row_mask:0xf bank_mask:0x4
    v_mfma_f32_16x16x32_bf16 v[32:35], v[152:155], v[20:23], v[32:35]
    s_nop 0
    v_add_f32_dpp v43, v29, v43 row_ror:4 row_mask:0xf bank_mask:0x4
    s_nop 1
    v_add_f32_dpp v43, v31, v43 row_ror:12 row_mask:0xf bank_mask:0x4
    v_mfma_f32_16x16x32_bf16 v[28:31], v[160:163], v[8:11], 0
    v_mfma_f32_16x16x32_bf16 v[28:31], v[164:167], v[12:15], v[28:31]
    s_waitcnt vmcnt(4)
    buffer_load_dwordx4 v[164:167], v6, s[44:47], s64 offen offset:1024 nt
    v_mfma_f32_16x16x32_bf16 v[28:31], v[172:175], v[16:19], v[28:31]
    v_mov_b32_dpp v43, v35 quad_perm:[0,1,2,3] row_mask:0xf bank_mask:0x8
    s_nop 1
    v_add_f32_dpp v43, v32, v43 row_ror:12 row_mask:0xf bank_mask:0x8
    v_mfma_f32_16x16x32_bf16 v[28:31], v[176:179], v[20:23], v[28:31]
    s_nop 0
    v_add_f32_dpp v43, v33, v43 row_ror:8 row_mask:0xf bank_mask:0x8
    s_nop 1
    v_add_f32_dpp v43, v34, v43 row_ror:4 row_mask:0xf bank_mask:0x8
    v_mfma_f32_16x16x32_bf16 v[32:35], v[184:187], v[8:11], 0
    s_waitcnt vmcnt(4)
    buffer_load_dwordx4 v[184:187], v6, s[44:47], s64 offen offset:2048 nt
    v_mfma_f32_16x16x32_bf16 v[32:35], v[188:191], v[12:15], v[32:35]
    v_mfma_f32_16x16x32_bf16 v[32:35], v[196:199], v[16:19], v[32:35]
    v_mov_b32_dpp v44, v28 quad_perm:[0,1,2,3] row_mask:0xf bank_mask:0x1
    s_nop 1
    v_add_f32_dpp v44, v29, v44 row_ror:12 row_mask:0xf bank_mask:0x1
    v_mfma_f32_16x16x32_bf16 v[32:35], v[200:203], v[20:23], v[32:35]
    s_nop 0
    v_add_f32_dpp v44, v30, v44 row_ror:8 row_mask:0xf bank_mask:0x1
    s_waitcnt vmcnt(4)
    buffer_load_dwordx4 v[200:203], v6, s[44:47], s64 offen offset:3072 nt
    s_addk_i32 s64, 0x4000
    v_add_f32_dpp v44, v31, v44 row_ror:4 row_mask:0xf bank_mask:0x1
    v_mfma_f32_16x16x32_bf16 v[28:31], v[208:211], v[8:11], 0
    v_mfma_f32_16x16x32_bf16 v[28:31], v[212:215], v[12:15], v[28:31]
    v_mfma_f32_16x16x32_bf16 v[28:31], v[220:223], v[16:19], v[28:31]
    v_mov_b32_dpp v44, v33 quad_perm:[0,1,2,3] row_mask:0xf bank_mask:0x2
    s_waitcnt vmcnt(4)
    buffer_load_dwordx4 v[196:199], v6, s[44:47], s64 offen offset:0 nt
    v_add_f32_dpp v44, v32, v44 row_ror:4 row_mask:0xf bank_mask:0x2
    v_mfma_f32_16x16x32_bf16 v[28:31], v[224:227], v[20:23], v[28:31]
    s_nop 0
    v_add_f32_dpp v44, v34, v44 row_ror:12 row_mask:0xf bank_mask:0x2
    s_nop 1
    v_add_f32_dpp v44, v35, v44 row_ror:8 row_mask:0xf bank_mask:0x2
    v_mfma_f32_16x16x32_bf16 v[32:35], v[72:75], v[8:11], 0
    v_mfma_f32_16x16x32_bf16 v[32:35], v[84:87], v[12:15], v[32:35]
    s_waitcnt vmcnt(4)
    buffer_load_dwordx4 v[84:87], v6, s[44:47], s64 offen offset:1024 nt
    v_mfma_f32_16x16x32_bf16 v[32:35], v[96:99], v[16:19], v[32:35]
    v_mov_b32_dpp v44, v30 quad_perm:[0,1,2,3] row_mask:0xf bank_mask:0x4
    s_nop 1
    v_add_f32_dpp v44, v28, v44 row_ror:8 row_mask:0xf bank_mask:0x4
    v_mfma_f32_16x16x32_bf16 v[32:35], v[108:111], v[20:23], v[32:35]
    s_nop 0
    v_add_f32_dpp v44, v29, v44 row_ror:4 row_mask:0xf bank_mask:0x4
    s_nop 1
    v_add_f32_dpp v44, v31, v44 row_ror:12 row_mask:0xf bank_mask:0x4
    v_mfma_f32_16x16x32_bf16 v[28:31], v[120:123], v[8:11], 0
    s_waitcnt vmcnt(4)
    buffer_load_dwordx4 v[120:123], v6, s[44:47], s64 offen offset:2048 nt
    v_mfma_f32_16x16x32_bf16 v[28:31], v[132:135], v[12:15], v[28:31]
    v_mfma_f32_16x16x32_bf16 v[28:31], v[144:147], v[16:19], v[28:31]
    v_mov_b32_dpp v44, v35 quad_perm:[0,1,2,3] row_mask:0xf bank_mask:0x8
    s_nop 1
    v_add_f32_dpp v44, v32, v44 row_ror:12 row_mask:0xf bank_mask:0x8
    v_mfma_f32_16x16x32_bf16 v[28:31], v[156:159], v[20:23], v[28:31]
    s_nop 0
    v_add_f32_dpp v44, v33, v44 row_ror:8 row_mask:0xf bank_mask:0x8
    s_waitcnt vmcnt(4)
    buffer_load_dwordx4 v[156:159], v6, s[44:47], s64 offen offset:3072 nt
    s_addk_i32 s64, 0x4000
    v_add_f32_dpp v44, v34, v44 row_ror:4 row_mask:0xf bank_mask:0x8
    v_mfma_f32_16x16x32_bf16 v[32:35], v[168:171], v[8:11], 0
    v_mfma_f32_16x16x32_bf16 v[32:35], v[180:183], v[12:15], v[32:35]
    v_mfma_f32_16x16x32_bf16 v[32:35], v[192:195], v[16:19], v[32:35]
    v_mov_b32_dpp v45, v28 quad_perm:[0,1,2,3] row_mask:0xf bank_mask:0x1
    s_waitcnt vmcnt(4)
    buffer_load_dwordx4 v[192:195], v6, s[44:47], s64 offen offset:0 nt
    v_add_f32_dpp v45, v29, v45 row_ror:12 row_mask:0xf bank_mask:0x1
    v_mfma_f32_16x16x32_bf16 v[32:35], v[204:207], v[20:23], v[32:35]
    s_nop 0
    v_add_f32_dpp v45, v30, v45 row_ror:8 row_mask:0xf bank_mask:0x1
    s_nop 1
    v_add_f32_dpp v45, v31, v45 row_ror:4 row_mask:0xf bank_mask:0x1
    v_mfma_f32_16x16x32_bf16 v[28:31], v[216:219], v[8:11], 0
    v_mfma_f32_16x16x32_bf16 v[28:31], v[228:231], v[12:15], v[28:31]
    s_waitcnt vmcnt(4)
    buffer_load_dwordx4 v[204:207], v6, s[44:47], s64 offen offset:1024 nt
    v_mfma_f32_16x16x32_bf16 v[28:31], v[240:243], v[16:19], v[28:31]
    v_mov_b32_dpp v45, v33 quad_perm:[0,1,2,3] row_mask:0xf bank_mask:0x2
    s_nop 1
    v_add_f32_dpp v45, v32, v45 row_ror:4 row_mask:0xf bank_mask:0x2
    v_mfma_f32_16x16x32_bf16 v[28:31], v[252:255], v[20:23], v[28:31]
    s_nop 0
    v_add_f32_dpp v45, v34, v45 row_ror:12 row_mask:0xf bank_mask:0x2
    s_nop 1
    v_add_f32_dpp v45, v35, v45 row_ror:8 row_mask:0xf bank_mask:0x2
    v_mfma_f32_16x16x32_bf16 v[32:35], v[76:79], v[8:11], 0
    s_waitcnt vmcnt(4)
    buffer_load_dwordx4 v[76:79], v6, s[44:47], s64 offen offset:2048 nt
    v_mfma_f32_16x16x32_bf16 v[32:35], v[92:95], v[12:15], v[32:35]
    v_mfma_f32_16x16x32_bf16 v[32:35], v[112:115], v[16:19], v[32:35]
    v_mov_b32_dpp v45, v30 quad_perm:[0,1,2,3] row_mask:0xf bank_mask:0x4
    s_nop 1
    v_add_f32_dpp v45, v28, v45 row_ror:8 row_mask:0xf bank_mask:0x4
    v_mfma_f32_16x16x32_bf16 v[32:35], v[128:131], v[20:23], v[32:35]
    s_nop 0
    v_add_f32_dpp v45, v29, v45 row_ror:4 row_mask:0xf bank_mask:0x4
    s_waitcnt vmcnt(4)
    buffer_load_dwordx4 v[128:131], v6, s[44:47], s64 offen offset:3072 nt
    s_addk_i32 s64, 0x4000
    v_add_f32_dpp v45, v31, v45 row_ror:12 row_mask:0xf bank_mask:0x4
    v_mfma_f32_16x16x32_bf16 v[28:31], v[148:151], v[8:11], 0
    v_mfma_f32_16x16x32_bf16 v[28:31], v[164:167], v[12:15], v[28:31]
    v_mfma_f32_16x16x32_bf16 v[28:31], v[184:187], v[16:19], v[28:31]
    v_mov_b32_dpp v45, v35 quad_perm:[0,1,2,3] row_mask:0xf bank_mask:0x8
    s_waitcnt vmcnt(4)
    buffer_load_dwordx4 v[184:187], v6, s[44:47], s64 offen offset:0 nt
    v_add_f32_dpp v45, v32, v45 row_ror:12 row_mask:0xf bank_mask:0x8
    v_mfma_f32_16x16x32_bf16 v[28:31], v[200:203], v[20:23], v[28:31]
    s_nop 0
    v_add_f32_dpp v45, v33, v45 row_ror:8 row_mask:0xf bank_mask:0x8
    s_nop 1
    v_add_f32_dpp v45, v34, v45 row_ror:4 row_mask:0xf bank_mask:0x8
    v_mfma_f32_16x16x32_bf16 v[32:35], v[196:199], v[8:11], 0
    v_mfma_f32_16x16x32_bf16 v[32:35], v[84:87], v[12:15], v[32:35]
    s_waitcnt vmcnt(4)
    buffer_load_dwordx4 v[84:87], v6, s[44:47], s64 offen offset:1024 nt
    v_mfma_f32_16x16x32_bf16 v[32:35], v[120:123], v[16:19], v[32:35]
    v_mov_b32_dpp v46, v28 quad_perm:[0,1,2,3] row_mask:0xf bank_mask:0x1
    s_nop 1
    v_add_f32_dpp v46, v29, v46 row_ror:12 row_mask:0xf bank_mask:0x1
    v_mfma_f32_16x16x32_bf16 v[32:35], v[156:159], v[20:23], v[32:35]
    s_nop 0
    v_add_f32_dpp v46, v30, v46 row_ror:8 row_mask:0xf bank_mask:0x1
    s_nop 1
    v_add_f32_dpp v46, v31, v46 row_ror:4 row_mask:0xf bank_mask:0x1
    s_waitcnt vmcnt(4)
    buffer_load_dwordx4 v[156:159], v6, s[44:47], s64 offen offset:2048 nt
    v_mfma_f32_16x16x32_bf16 v[28:31], v[192:195], v[8:11], 0
    s_waitcnt vmcnt(4)
    buffer_load_dwordx4 v[192:195], v6, s[44:47], s64 offen offset:3072 nt
    s_addk_i32 s64, 0x4000
    v_mfma_f32_16x16x32_bf16 v[28:31], v[204:207], v[12:15], v[28:31]
    s_waitcnt vmcnt(4)
    buffer_load_dwordx4 v[204:207], v6, s[44:47], s64 offen offset:0 nt
    v_mfma_f32_16x16x32_bf16 v[28:31], v[76:79], v[16:19], v[28:31]
    v_mov_b32_dpp v46, v33 quad_perm:[0,1,2,3] row_mask:0xf bank_mask:0x2
    s_nop 1
    v_add_f32_dpp v46, v32, v46 row_ror:4 row_mask:0xf bank_mask:0x2
    s_waitcnt vmcnt(4)
    buffer_load_dwordx4 v[76:79], v6, s[44:47], s64 offen offset:1024 nt
    v_mfma_f32_16x16x32_bf16 v[28:31], v[128:131], v[20:23], v[28:31]
    v_add_f32_dpp v46, v34, v46 row_ror:12 row_mask:0xf bank_mask:0x2
    s_nop 1
    v_add_f32_dpp v46, v35, v46 row_ror:8 row_mask:0xf bank_mask:0x2
    s_waitcnt vmcnt(4)
    buffer_load_dwordx4 v[128:131], v6, s[44:47], s64 offen offset:2048 nt
    v_mfma_f32_16x16x32_bf16 v[32:35], v[184:187], v[8:11], 0
    s_waitcnt vmcnt(4)
    buffer_load_dwordx4 v[184:187], v6, s[44:47], s64 offen offset:3072 nt
    s_addk_i32 s64, 0x4000
    v_mfma_f32_16x16x32_bf16 v[32:35], v[84:87], v[12:15], v[32:35]
    s_waitcnt vmcnt(4)
    buffer_load_dwordx4 v[84:87], v6, s[44:47], s64 offen offset:0 nt
    v_mfma_f32_16x16x32_bf16 v[32:35], v[156:159], v[16:19], v[32:35]
    v_mov_b32_dpp v46, v30 quad_perm:[0,1,2,3] row_mask:0xf bank_mask:0x4
    s_nop 1
    v_add_f32_dpp v46, v28, v46 row_ror:8 row_mask:0xf bank_mask:0x4
    s_waitcnt vmcnt(4)
    buffer_load_dwordx4 v[156:159], v6, s[44:47], s64 offen offset:1024 nt
    v_mfma_f32_16x16x32_bf16 v[32:35], v[192:195], v[20:23], v[32:35]
    v_add_f32_dpp v46, v29, v46 row_ror:4 row_mask:0xf bank_mask:0x4
    s_nop 1
    v_add_f32_dpp v46, v31, v46 row_ror:12 row_mask:0xf bank_mask:0x4
    s_waitcnt vmcnt(4)
    buffer_load_dwordx4 v[192:195], v6, s[44:47], s64 offen offset:2048 nt
    v_mfma_f32_16x16x32_bf16 v[28:31], v[204:207], v[8:11], 0
    s_cmp_eq_u32 s75, 32
    s_cbranch_scc1 L_var32
    s_cmp_eq_u32 s75, 33
    s_cbranch_scc1 L_var33
L_var30:
    s_waitcnt vmcnt(4)
    buffer_load_dwordx4 v[204:207], v6, s[44:47], s64 offen offset:3072 nt
    s_addk_i32 s64, 0x4000
    v_mfma_f32_16x16x32_bf16 v[28:31], v[76:79], v[12:15], v[28:31]
    s_waitcnt vmcnt(4)
    buffer_load_dwordx4 v[208:211], v7, s[48:51], s65 offen offset:0 nt
    v_mfma_f32_16x16x32_bf16 v[28:31], v[128:131], v[16:19], v[28:31]
    v_mov_b32_dpp v46, v35 quad_perm:[0,1,2,3] row_mask:0xf bank_mask:0x8
    s_nop 1
    v_add_f32_dpp v46, v32, v46 row_ror:12 row_mask:0xf bank_mask:0x8
    s_waitcnt vmcnt(4)
    buffer_load_dwordx4 v[212:215], v7, s[48:51], s65 offen offset:1024 nt
    v_mfma_f32_16x16x32_bf16 v[28:31], v[184:187], v[20:23], v[28:31]
    v_add_f32_dpp v46, v33, v46 row_ror:8 row_mask:0xf bank_mask:0x8
    s_nop 1
    v_add_f32_dpp v46, v34, v46 row_ror:4 row_mask:0xf bank_mask:0x8
    s_waitcnt vmcnt(4)
    buffer_load_dwordx4 v[216:219], v7, s[48:51], s65 offen offset:2048 nt
    v_mfma_f32_16x16x32_bf16 v[32:35], v[84:87], v[8:11], 0
    s_waitcnt vmcnt(4)
    buffer_load_dwordx4 v[220:223], v7, s[48:51], s65 offen offset:3072 nt
    s_addk_i32 s65, 0x4000
    v_mfma_f32_16x16x32_bf16 v[32:35], v[156:159], v[12:15], v[32:35]
    s_waitcnt vmcnt(4)
    buffer_load_dwordx4 v[224:227], v7, s[48:51], s65 offen offset:0 nt
    v_mfma_f32_16x16x32_bf16 v[32:35], v[192:195], v[16:19], v[32:35]
    v_mov_b32_dpp v47, v28 quad_perm:[0,1,2,3] row_mask:0xf bank_mask:0x1
    s_nop 1
    v_add_f32_dpp v47, v29, v47 row_ror:12 row_mask:0xf bank_mask:0x1
    s_waitcnt vmcnt(4)
    buffer_load_dwordx4 v[228:231], v7, s[48:51], s65 offen offset:1024 nt
    v_mfma_f32_16x16x32_bf16 v[32:35], v[204:207], v[20:23], v[32:35]
    v_add_f32_dpp v47, v30, v47 row_ror:8 row_mask:0xf bank_mask:0x1
    s_nop 1
    v_add_f32_dpp v47, v31, v47 row_ror:4 row_mask:0xf bank_mask:0x1
    s_nop 3
    v_mov_b32_dpp v47, v33 quad_perm:[0,1,2,3] row_mask:0xf bank_mask:0x2
    s_nop 1
    v_add_f32_dpp v47, v32, v47 row_ror:4 row_mask:0xf bank_mask:0x2
    s_nop 1
    v_add_f32_dpp v47, v34, v47 row_ror:12 row_mask:0xf bank_mask:0x2
    s_nop 1
    v_add_f32_dpp v47, v35, v47 row_ror:8 row_mask:0xf bank_mask:0x2
    s_branch L_soft
L_var32:
    s_waitcnt vmcnt(4)
    buffer_load_dwordx4 v[204:207], v6, s[44:47], s64 offen offset:3072 nt
    s_addk_i32 s64, 0x4000
    v_mfma_f32_16x16x32_bf16 v[28:31], v[76:79], v[12:15], v[28:31]
    s_waitcnt vmcnt(4)
    buffer_load_dwordx4 v[76:79], v6, s[44:47], s64 offen offset:0 nt
    v_mfma_f32_16x16x32_bf16 v[28:31], v[128:131], v[16:19], v[28:31]
    v_mov_b32_dpp v46, v35 quad_perm:[0,1,2,3] row_mask:0xf bank_mask:0x8
    s_nop 1
    v_add_f32_dpp v46, v32, v46 row_ror:12 row_mask:0xf bank_mask:0x8
    s_waitcnt vmcnt(4)
    buffer_load_dwordx4 v[128:131], v6, s[44:47], s64 offen offset:1024 nt
    v_mfma_f32_16x16x32_bf16 v[28:31], v[184:187], v[20:23], v[28:31]
    v_add_f32_dpp v46, v33, v46 row_ror:8 row_mask:0xf bank_mask:0x8
    s_nop 1
    v_add_f32_dpp v46, v34, v46 row_ror:4 row_mask:0xf bank_mask:0x8
    s_waitcnt vmcnt(4)
    buffer_load_dwordx4 v[184:187], v6, s[44:47], s64 offen offset:2048 nt
    v_mfma_f32_16x16x32_bf16 v[32:35], v[84:87], v[8:11], 0
    s_waitcnt vmcnt(4)
    buffer_load_dwordx4 v[84:87], v6, s[44:47], s64 offen offset:3072 nt
    s_addk_i32 s64, 0x4000
    v_mfma_f32_16x16x32_bf16 v[32:35], v[156:159], v[12:15], v[32:35]
    s_waitcnt vmcnt(4)
    buffer_load_dwordx4 v[156:159], v6, s[44:47], s64 offen offset:0 nt
    v_mfma_f32_16x16x32_bf16 v[32:35], v[192:195], v[16:19], v[32:35]
    v_mov_b32_dpp v47, v28 quad_perm:[0,1,2,3] row_mask:0xf bank_mask:0x1
    s_nop 1
    v_add_f32_dpp v47, v29, v47 row_ror:12 row_mask:0xf bank_mask:0x1
    s_waitcnt vmcnt(4)
    buffer_load_dwordx4 v[192:195], v6, s[44:47], s64 offen offset:1024 nt
    v_mfma_f32_16x16x32_bf16 v[32:35], v[204:207], v[20:23], v[32:35]
    v_add_f32_dpp v47, v30, v47 row_ror:8 row_mask:0xf bank_mask:0x1
    s_nop 1
    v_add_f32_dpp v47, v31, v47 row_ror:4 row_mask:0xf bank_mask:0x1
    s_waitcnt vmcnt(4)
    buffer_load_dwordx4 v[204:207], v6, s[44:47], s64 offen offset:2048 nt
    v_mfma_f32_16x16x32_bf16 v[28:31], v[76:79], v[8:11], 0
    s_waitcnt vmcnt(4)
    buffer_load_dwordx4 v[76:79], v6, s[44:47], s64 offen offset:3072 nt
    s_addk_i32 s64, 0x4000
    v_mfma_f32_16x16x32_bf16 v[28:31], v[128:131], v[12:15], v[28:31]
    s_waitcnt vmcnt(4)
    buffer_load_dwordx4 v[208:211], v7, s[48:51], s65 offen offset:0 nt
    v_mfma_f32_16x16x32_bf16 v[28:31], v[184:187], v[16:19], v[28:31]
    v_mov_b32_dpp v47, v33 quad_perm:[0,1,2,3] row_mask:0xf bank_mask:0x2
    s_nop 1
    v_add_f32_dpp v47, v32, v47 row_ror:4 row_mask:0xf bank_mask:0x2
    s_waitcnt vmcnt(4)
    buffer_load_dwordx4 v[212:215], v7, s[48:51], s65 offen offset:1024 nt
    v_mfma_f32_16x16x32_bf16 v[28:31], v[84:87], v[20:23], v[28:31]
    v_add_f32_dpp v47, v34, v47 row_ror:12 row_mask:0xf bank_mask:0x2
    s_nop 1
    v_add_f32_dpp v47, v35, v47 row_ror:8 row_mask:0xf bank_mask:0x2
    s_waitcnt vmcnt(4)
    buffer_load_dwordx4 v[216:219], v7, s[48:51], s65 offen offset:2048 nt
    v_mfma_f32_16x16x32_bf16 v[32:35], v[156:159], v[8:11], 0
    s_waitcnt vmcnt(4)
    buffer_load_dwordx4 v[220:223], v7, s[48:51], s65 offen offset:3072 nt
    s_addk_i32 s65, 0x4000
    v_mfma_f32_16x16x32_bf16 v[32:35], v[192:195], v[12:15], v[32:35]
    s_waitcnt vmcnt(4)
    buffer_load_dwordx4 v[224:227], v7, s[48:51], s65 offen offset:0 nt
    v_mfma_f32_16x16x32_bf16 v[32:35], v[204:207], v[16:19], v[32:35]
    v_mov_b32_dpp v47, v30 quad_perm:[0,1,2,3] row_mask:0xf bank_mask:0x4
    s_nop 1
    v_add_f32_dpp v47, v28, v47 row_ror:8 row_mask:0xf bank_mask:0x4
    s_waitcnt vmcnt(4)
    buffer_load_dwordx4 v[228:231], v7, s[48:51], s65 offen offset:1024 nt
    v_mfma_f32_16x16x32_bf16 v[32:35], v[76:79], v[20:23], v[32:35]
    v_add_f32_dpp v47, v29, v47 row_ror:4 row_mask:0xf bank_mask:0x4
    s_nop 1
    v_add_f32_dpp v47, v31, v47 row_ror:12 row_mask:0xf bank_mask:0x4
    s_nop 3
    v_mov_b32_dpp v47, v35 quad_perm:[0,1,2,3] row_mask:0xf bank_mask:0x8
    s_nop 1
    v_add_f32_dpp v47, v32, v47 row_ror:12 row_mask:0xf bank_mask:0x8
    s_nop 1
    v_add_f32_dpp v47, v33, v47 row_ror:8 row_mask:0xf bank_mask:0x8
    s_nop 1
    v_add_f32_dpp v47, v34, v47 row_ror:4 row_mask:0xf bank_mask:0x8
    s_branch L_soft
L_var33:
    s_waitcnt vmcnt(4)
    buffer_load_dwordx4 v[204:207], v6, s[44:47], s64 offen offset:3072 nt
    s_addk_i32 s64, 0x4000
    v_mfma_f32_16x16x32_bf16 v[28:31], v[76:79], v[12:15], v[28:31]
    s_waitcnt vmcnt(4)
    buffer_load_dwordx4 v[76:79], v6, s[44:47], s64 offen offset:0 nt
    v_mfma_f32_16x16x32_bf16 v[28:31], v[128:131], v[16:19], v[28:31]
    v_mov_b32_dpp v46, v35 quad_perm:[0,1,2,3] row_mask:0xf bank_mask:0x8
    s_nop 1
    v_add_f32_dpp v46, v32, v46 row_ror:12 row_mask:0xf bank_mask:0x8
    s_waitcnt vmcnt(4)
    buffer_load_dwordx4 v[128:131], v6, s[44:47], s64 offen offset:1024 nt
    v_mfma_f32_16x16x32_bf16 v[28:31], v[184:187], v[20:23], v[28:31]
    v_add_f32_dpp v46, v33, v46 row_ror:8 row_mask:0xf bank_mask:0x8
    s_nop 1
    v_add_f32_dpp v46, v34, v46 row_ror:4 row_mask:0xf bank_mask:0x8
    s_waitcnt vmcnt(4)
    buffer_load_dwordx4 v[184:187], v6, s[44:47], s64 offen offset:2048 nt
    v_mfma_f32_16x16x32_bf16 v[32:35], v[84:87], v[8:11], 0
    s_waitcnt vmcnt(4)
    buffer_load_dwordx4 v[84:87], v6, s[44:47], s64 offen offset:3072 nt
    s_addk_i32 s64, 0x4000
    v_mfma_f32_16x16x32_bf16 v[32:35], v[156:159], v[12:15], v[32:35]
    s_waitcnt vmcnt(4)
    buffer_load_dwordx4 v[156:159], v6, s[44:47], s64 offen offset:0 nt
    v_mfma_f32_16x16x32_bf16 v[32:35], v[192:195], v[16:19], v[32:35]
    v_mov_b32_dpp v47, v28 quad_perm:[0,1,2,3] row_mask:0xf bank_mask:0x1
    s_nop 1
    v_add_f32_dpp v47, v29, v47 row_ror:12 row_mask:0xf bank_mask:0x1
    s_waitcnt vmcnt(4)
    buffer_load_dwordx4 v[192:195], v6, s[44:47], s64 offen offset:1024 nt
    v_mfma_f32_16x16x32_bf16 v[32:35], v[204:207], v[20:23], v[32:35]
    v_add_f32_dpp v47, v30, v47 row_ror:8 row_mask:0xf bank_mask:0x1
    s_nop 1
    v_add_f32_dpp v47, v31, v47 row_ror:4 row_mask:0xf bank_mask:0x1
    s_waitcnt vmcnt(4)
    buffer_load_dwordx4 v[204:207], v6, s[44:47], s64 offen offset:2048 nt
    v_mfma_f32_16x16x32_bf16 v[28:31], v[76:79], v[8:11], 0
    s_waitcnt vmcnt(4)
    buffer_load_dwordx4 v[76:79], v6, s[44:47], s64 offen offset:3072 nt
    s_addk_i32 s64, 0x4000
    v_mfma_f32_16x16x32_bf16 v[28:31], v[128:131], v[12:15], v[28:31]
    s_waitcnt vmcnt(4)
    buffer_load_dwordx4 v[128:131], v6, s[44:47], s64 offen offset:0 nt
    v_mfma_f32_16x16x32_bf16 v[28:31], v[184:187], v[16:19], v[28:31]
    v_mov_b32_dpp v47, v33 quad_perm:[0,1,2,3] row_mask:0xf bank_mask:0x2
    s_nop 1
    v_add_f32_dpp v47, v32, v47 row_ror:4 row_mask:0xf bank_mask:0x2
    s_waitcnt vmcnt(4)
    buffer_load_dwordx4 v[184:187], v6, s[44:47], s64 offen offset:1024 nt
    v_mfma_f32_16x16x32_bf16 v[28:31], v[84:87], v[20:23], v[28:31]
    v_add_f32_dpp v47, v34, v47 row_ror:12 row_mask:0xf bank_mask:0x2
    s_nop 1
    v_add_f32_dpp v47, v35, v47 row_ror:8 row_mask:0xf bank_mask:0x2
    s_waitcnt vmcnt(4)
    buffer_load_dwordx4 v[84:87], v6, s[44:47], s64 offen offset:2048 nt
    v_mfma_f32_16x16x32_bf16 v[32:35], v[156:159], v[8:11], 0
    s_waitcnt vmcnt(4)
    buffer_load_dwordx4 v[156:159], v6, s[44:47], s64 offen offset:3072 nt
    s_addk_i32 s64, 0x4000
    v_mfma_f32_16x16x32_bf16 v[32:35], v[192:195], v[12:15], v[32:35]
    s_waitcnt vmcnt(4)
    buffer_load_dwordx4 v[208:211], v7, s[48:51], s65 offen offset:0 nt
    v_mfma_f32_16x16x32_bf16 v[32:35], v[204:207], v[16:19], v[32:35]
    v_mov_b32_dpp v47, v30 quad_perm:[0,1,2,3] row_mask:0xf bank_mask:0x4
    s_nop 1
    v_add_f32_dpp v47, v28, v47 row_ror:8 row_mask:0xf bank_mask:0x4
    s_waitcnt vmcnt(4)
    buffer_load_dwordx4 v[212:215], v7, s[48:51], s65 offen offset:1024 nt
    v_mfma_f32_16x16x32_bf16 v[32:35], v[76:79], v[20:23], v[32:35]
    v_add_f32_dpp v47, v29, v47 row_ror:4 row_mask:0xf bank_mask:0x4
    s_nop 1
    v_add_f32_dpp v47, v31, v47 row_ror:12 row_mask:0xf bank_mask:0x4
    s_waitcnt vmcnt(4)
    buffer_load_dwordx4 v[216:219], v7, s[48:51], s65 offen offset:2048 nt
    v_mfma_f32_16x16x32_bf16 v[28:31], v[128:131], v[8:11], 0
    s_waitcnt vmcnt(4)
    buffer_load_dwordx4 v[220:223], v7, s[48:51], s65 offen offset:3072 nt
    s_addk_i32 s65, 0x4000
    v_mfma_f32_16x16x32_bf16 v[28:31], v[184:187], v[12:15], v[28:31]
    s_waitcnt vmcnt(4)
    buffer_load_dwordx4 v[224:227], v7, s[48:51], s65 offen offset:0 nt
    v_mfma_f32_16x16x32_bf16 v[28:31], v[84:87], v[16:19], v[28:31]
    v_mov_b32_dpp v47, v35 quad_perm:[0,1,2,3] row_mask:0xf bank_mask:0x8
    s_nop 1
    v_add_f32_dpp v47, v32, v47 row_ror:12 row_mask:0xf bank_mask:0x8
    s_waitcnt vmcnt(4)
    buffer_load_dwordx4 v[228:231], v7, s[48:51], s65 offen offset:1024 nt
    v_mfma_f32_16x16x32_bf16 v[28:31], v[156:159], v[20:23], v[28:31]
    v_add_f32_dpp v47, v33, v47 row_ror:8 row_mask:0xf bank_mask:0x8
    s_nop 1
    v_add_f32_dpp v47, v34, v47 row_ror:4 row_mask:0xf bank_mask:0x8
    s_nop 3
    v_mov_b32_dpp v48, v28 quad_perm:[0,1,2,3] row_mask:0xf bank_mask:0x1
    s_nop 1
    v_add_f32_dpp v48, v29, v48 row_ror:12 row_mask:0xf bank_mask:0x1
    s_nop 1
    v_add_f32_dpp v48, v30, v48 row_ror:8 row_mask:0xf bank_mask:0x1
    s_nop 1
    v_add_f32_dpp v48, v31, v48 row_ror:4 row_mask:0xf bank_mask:0x1
L_soft:
    s_nop 1
    s_mov_b32 s12, 0x3db504f3
    s_mov_b32 s13, 0x3fb8aa3b
    v_cvt_pk_bf16_f32 v8, v40, v41
    v_cvt_pk_bf16_f32 v9, v42, v43
    v_cvt_pk_bf16_f32 v10, v44, v45
    v_cvt_pk_bf16_f32 v11, v46, v47
    v_cvt_pk_bf16_f32 v12, v48, v48
    v_lshlrev_b32 v40, 16, v8
    v_and_b32 v41, 0xffff0000, v8
    v_lshlrev_b32 v42, 16, v9
    v_and_b32 v43, 0xffff0000, v9
    v_lshlrev_b32 v44, 16, v10
    v_and_b32 v45, 0xffff0000, v10
    v_lshlrev_b32 v46, 16, v11
    v_and_b32 v47, 0xffff0000, v11
    v_lshlrev_b32 v48, 16, v12
    v_mul_f32 v40, s12, v40
    v_mul_f32 v41, s12, v41
    v_mul_f32 v42, s12, v42
    v_mul_f32 v43, s12, v43
    v_mul_f32 v44, s12, v44
    v_mul_f32 v45, s12, v45
    v_mul_f32 v46, s12, v46
    v_mul_f32 v47, s12, v47
    v_mul_f32 v48, s12, v48
    v_cvt_pk_bf16_f32 v8, v40, v41
    v_cvt_pk_bf16_f32 v9, v42, v43
    v_cvt_pk_bf16_f32 v10, v44, v45
    v_cvt_pk_bf16_f32 v11, v46, v47
    v_cvt_pk_bf16_f32 v12, v48, v48
    v_lshlrev_b32 v40, 16, v8
    v_and_b32 v41, 0xffff0000, v8
    v_lshlrev_b32 v42, 16, v9
    v_and_b32 v43, 0xffff0000, v9
    v_lshlrev_b32 v44, 16, v10
    v_and_b32 v45, 0xffff0000, v10
    v_lshlrev_b32 v46, 16, v11
    v_and_b32 v47, 0xffff0000, v11
    v_lshlrev_b32 v48, 16, v12
    v_max3_f32 v8, v40, v41, v42
    v_max3_f32 v9, v43, v44, v45
    v_max3_f32 v8, v8, v46, v47
    v_max_f32 v9, v9, v48
    v_max_f32 v8, v8, v9
    s_nop 1
    v_max_f32_dpp v8, v8, v8 row_ror:8 row_mask:0xf bank_mask:0xf
    s_nop 1
    v_max_f32_dpp v8, v8, v8 row_ror:4 row_mask:0xf bank_mask:0xf
    s_nop 1
    v_max_f32_dpp v8, v8, v8 row_ror:2 row_mask:0xf bank_mask:0xf
    s_nop 1
    v_max_f32_dpp v8, v8, v8 row_ror:1 row_mask:0xf bank_mask:0xf
    s_nop 1
    v_max_f32_dpp v8, v8, v8 row_bcast:15 row_mask:0xa bank_mask:0xf
    s_nop 1
    v_max_f32_dpp v8, v8, v8 row_bcast:31 row_mask:0xc bank_mask:0xf
    s_nop 0
    v_readlane_b32 s73, v8, 63
    s_nop 1
    v_subrev_f32 v40, s73, v40
    v_subrev_f32 v41, s73, v41
    v_subrev_f32 v42, s73, v42
    v_subrev_f32 v43, s73, v43
    v_subrev_f32 v44, s73, v44
    v_subrev_f32 v45, s73, v45
    v_subrev_f32 v46, s73, v46
    v_subrev_f32 v47, s73, v47
    v_subrev_f32 v48, s73, v48
    v_mul_f32 v40, s13, v40
    v_mul_f32 v41, s13, v41
    v_mul_f32 v42, s13, v42
    v_mul_f32 v43, s13, v43
    v_mul_f32 v44, s13, v44
    v_mul_f32 v45, s13, v45
    v_mul_f32 v46, s13, v46
    v_mul_f32 v47, s13, v47
    v_mul_f32 v48, s13, v48
    v_exp_f32 v40, v40
    v_exp_f32 v41, v41
    v_exp_f32 v42, v42
    v_exp_f32 v43, v43
    v_exp_f32 v44, v44
    v_exp_f32 v45, v45
    v_exp_f32 v46, v46
    v_exp_f32 v47, v47
    v_exp_f32 v48, v48
    v_add_f32 v8, v40, v41
    v_add_f32 v9, v42, v43
    v_add_f32 v10, v44, v45
    v_add_f32 v11, v46, v47
    v_add_f32 v8, v8, v9
    v_add_f32 v10, v10, v11
    v_add_f32 v8, v8, v48
    v_add_f32 v18, v8, v10
    v_cvt_pk_bf16_f32 v40, v40, v40
    v_cvt_pk_bf16_f32 v41, v41, v41
    v_cvt_pk_bf16_f32 v42, v42, v42
    v_cvt_pk_bf16_f32 v43, v43, v43
    v_cvt_pk_bf16_f32 v44, v44, v44
    v_cvt_pk_bf16_f32 v45, v45, v45
    v_cvt_pk_bf16_f32 v46, v46, v46
    v_cvt_pk_bf16_f32 v47, v47, v47
    v_cvt_pk_bf16_f32 v48, v48, v48
    v_add_f32_dpp v18, v18, v18 row_ror:8 row_mask:0xf bank_mask:0xf
    s_nop 1
    v_add_f32_dpp v18, v18, v18 row_ror:4 row_mask:0xf bank_mask:0xf
    s_nop 1
    v_add_f32_dpp v18, v18, v18 row_ror:2 row_mask:0xf bank_mask:0xf
    s_nop 1
    v_add_f32_dpp v18, v18, v18 row_ror:1 row_mask:0xf bank_mask:0xf
    s_nop 1
    v_add_f32_dpp v18, v18, v18 row_bcast:15 row_mask:0xa bank_mask:0xf
    s_nop 1
    v_add_f32_dpp v18, v18, v18 row_bcast:31 row_mask:0xc bank_mask:0xf
    v_mov_b32 v16, s73
    v_mov_b32 v17, s10
    v_mov_b32 v19, s10
    s_lshl_b32 s12, s8, 5
    s_add_u32 s12, s12, s6
    s_lshl_b32 s12, s12, 8
    s_add_u32 s12, s12, 32768
    s_add_u32 s96, s42, s12
    s_addc_u32 s97, s43, 0
    s_lshl_b32 s13, s9, 6
    s_add_u32 s12, s12, s13
    s_lshl_b32 s13, s3, 4
    s_add_u32 s12, s12, s13
    v_mov_b32 v20, 0x7ff00000
    v_mov_b32 v21, 0
    v_cmp_eq_u32 vcc, 63, v1
    s_nop 1
    v_cndmask_b32 v20, v20, v21, vcc
    v_lshlrev_b32 v22, 3, v1
    v_add_u32 v22, 149728, v22
    buffer_store_dwordx4 v[16:19], v20, s[52:55], s12 offen sc1
    s_mul_i32 s12, s3, 272
    s_add_u32 s12, s12, 148640
    v_lshlrev_b32 v28, 4, v2
    v_lshl_add_u32 v28, v3, 3, v28
    v_add_u32 v28, s12, v28
    v_cmp_gt_u32 vcc, 32, v1
    s_nop 1
    v_cndmask_b32 v28, v22, v28, vcc
    v_mov_b32 v36, 0
    v_mov_b32 v37, 0
    v_mov_b32 v38, 0
    v_mov_b32 v39, 0
    s_mov_b64 s[44:45], s[16:17]
    s_mov_b64 s[46:47], s[38:39]
    s_sub_u32 s75, s75, 1
    s_mov_b32 s72, 0
    s_mov_b32 s70, 262144
    s_mov_b32 s13, 0x3fb8aa3b
    v_mov_b32 v30, s73
    v_mov_b32 v31, 0
    v_and_b32_dpp v8, v40, v24 row_newbcast:0 row_mask:0xf bank_mask:0xf
    v_and_b32_dpp v9, v40, v25 row_newbcast:0 row_mask:0xf bank_mask:0xf
    v_and_b32_dpp v10, v40, v26 row_newbcast:0 row_mask:0xf bank_mask:0xf
    v_and_b32_dpp v11, v40, v27 row_newbcast:0 row_mask:0xf bank_mask:0xf
L_vloop:
    s_waitcnt vmcnt(4)
    buffer_load_dwordx4 v[232:235], v7, s[48:51], s65 offen offset:2048 nt
    v_mfma_f32_16x16x32_bf16 v[36:39], v[8:11], v[208:211], v[36:39]
    v_and_b32_dpp v12, v40, v24 row_newbcast:1 row_mask:0xf bank_mask:0xf
    v_and_b32_dpp v13, v40, v25 row_newbcast:1 row_mask:0xf bank_mask:0xf
    v_and_b32_dpp v14, v40, v26 row_newbcast:1 row_mask:0xf bank_mask:0xf
    v_and_b32_dpp v15, v40, v27 row_newbcast:1 row_mask:0xf bank_mask:0xf
    s_waitcnt vmcnt(4)
    buffer_load_dwordx4 v[236:239], v7, s[48:51], s65 offen offset:3072 nt
    s_addk_i32 s65, 0x4000
    v_mfma_f32_16x16x32_bf16 v[36:39], v[12:15], v[212:215], v[36:39]
    v_and_b32_dpp v8, v40, v24 row_newbcast:2 row_mask:0xf bank_mask:0xf
    v_and_b32_dpp v9, v40, v25 row_newbcast:2 row_mask:0xf bank_mask:0xf
    v_and_b32_dpp v10, v40, v26 row_newbcast:2 row_mask:0xf bank_mask:0xf
    v_and_b32_dpp v11, v40, v27 row_newbcast:2 row_mask:0xf bank_mask:0xf
    s_waitcnt vmcnt(4)
    buffer_load_dwordx4 v[208:211], v7, s[48:51], s65 offen offset:0 nt
    v_mfma_f32_16x16x32_bf16 v[36:39], v[8:11], v[216:219], v[36:39]
    v_and_b32_dpp v12, v40, v24 row_newbcast:3 row_mask:0xf bank_mask:0xf
    v_and_b32_dpp v13, v40, v25 row_newbcast:3 row_mask:0xf bank_mask:0xf
    v_and_b32_dpp v14, v40, v26 row_newbcast:3 row_mask:0xf bank_mask:0xf
    v_and_b32_dpp v15, v40, v27 row_newbcast:3 row_mask:0xf bank_mask:0xf
    s_waitcnt vmcnt(4)
    buffer_load_dwordx4 v[212:215], v7, s[48:51], s65 offen offset:1024 nt
    v_mfma_f32_16x16x32_bf16 v[36:39], v[12:15], v[220:223], v[36:39]
    s_sub_u32 s75, s75, 1
    s_cbranch_scc1 L_vend
    v_and_b32_dpp v8, v40, v24 row_newbcast:4 row_mask:0xf bank_mask:0xf
    v_and_b32_dpp v9, v40, v25 row_newbcast:4 row_mask:0xf bank_mask:0xf
    v_and_b32_dpp v10, v40, v26 row_newbcast:4 row_mask:0xf bank_mask:0xf
    v_and_b32_dpp v11, v40, v27 row_newbcast:4 row_mask:0xf bank_mask:0xf
    s_waitcnt vmcnt(4)
    buffer_load_dwordx4 v[216:219], v7, s[48:51], s65 offen offset:2048 nt
    v_mfma_f32_16x16x32_bf16 v[36:39], v[8:11], v[224:227], v[36:39]
    v_and_b32_dpp v12, v40, v24 row_newbcast:5 row_mask:0xf bank_mask:0xf
    v_and_b32_dpp v13, v40, v25 row_newbcast:5 row_mask:0xf bank_mask:0xf
    v_and_b32_dpp v14, v40, v26 row_newbcast:5 row_mask:0xf bank_mask:0xf
    v_and_b32_dpp v15, v40, v27 row_newbcast:5 row_mask:0xf bank_mask:0xf
    s_waitcnt vmcnt(4)
    buffer_load_dwordx4 v[220:223], v7, s[48:51], s65 offen offset:3072 nt
    s_addk_i32 s65, 0x4000
    v_mfma_f32_16x16x32_bf16 v[36:39], v[12:15], v[228:231], v[36:39]
    v_and_b32_dpp v8, v40, v24 row_newbcast:6 row_mask:0xf bank_mask:0xf
    v_and_b32_dpp v9, v40, v25 row_newbcast:6 row_mask:0xf bank_mask:0xf
    v_and_b32_dpp v10, v40, v26 row_newbcast:6 row_mask:0xf bank_mask:0xf
    v_and_b32_dpp v11, v40, v27 row_newbcast:6 row_mask:0xf bank_mask:0xf
    s_waitcnt vmcnt(4)
    buffer_load_dwordx4 v[224:227], v7, s[48:51], s65 offen offset:0 nt
    v_mfma_f32_16x16x32_bf16 v[36:39], v[8:11], v[232:235], v[36:39]
    v_and_b32_dpp v12, v40, v24 row_newbcast:7 row_mask:0xf bank_mask:0xf
    v_and_b32_dpp v13, v40, v25 row_newbcast:7 row_mask:0xf bank_mask:0xf
    v_and_b32_dpp v14, v40, v26 row_newbcast:7 row_mask:0xf bank_mask:0xf
    v_and_b32_dpp v15, v40, v27 row_newbcast:7 row_mask:0xf bank_mask:0xf
    s_waitcnt vmcnt(4)
    buffer_load_dwordx4 v[228:231], v7, s[48:51], s65 offen offset:1024 nt
    v_mfma_f32_16x16x32_bf16 v[36:39], v[12:15], v[236:239], v[36:39]
    s_sub_u32 s75, s75, 1
    s_cbranch_scc1 L_vend
    v_and_b32_dpp v8, v40, v24 row_newbcast:8 row_mask:0xf bank_mask:0xf
    v_and_b32_dpp v9, v40, v25 row_newbcast:8 row_mask:0xf bank_mask:0xf
    v_and_b32_dpp v10, v40, v26 row_newbcast:8 row_mask:0xf bank_mask:0xf
    v_and_b32_dpp v11, v40, v27 row_newbcast:8 row_mask:0xf bank_mask:0xf
    s_waitcnt vmcnt(4)
    buffer_load_dwordx4 v[232:235], v7, s[48:51], s65 offen offset:2048 nt
    v_mfma_f32_16x16x32_bf16 v[36:39], v[8:11], v[208:211], v[36:39]
    v_and_b32_dpp v12, v40, v24 row_newbcast:9 row_mask:0xf bank_mask:0xf
    v_and_b32_dpp v13, v40, v25 row_newbcast:9 row_mask:0xf bank_mask:0xf
    v_and_b32_dpp v14, v40, v26 row_newbcast:9 row_mask:0xf bank_mask:0xf
    v_and_b32_dpp v15, v40, v27 row_newbcast:9 row_mask:0xf bank_mask:0xf
    s_waitcnt vmcnt(4)
    buffer_load_dwordx4 v[236:239], v7, s[48:51], s65 offen offset:3072 nt
    s_addk_i32 s65, 0x4000
    v_mfma_f32_16x16x32_bf16 v[36:39], v[12:15], v[212:215], v[36:39]
    v_and_b32_dpp v8, v40, v24 row_newbcast:10 row_mask:0xf bank_mask:0xf
    v_and_b32_dpp v9, v40, v25 row_newbcast:10 row_mask:0xf bank_mask:0xf
    v_and_b32_dpp v10, v40, v26 row_newbcast:10 row_mask:0xf bank_mask:0xf
    v_and_b32_dpp v11, v40, v27 row_newbcast:10 row_mask:0xf bank_mask:0xf
    s_waitcnt vmcnt(4)
    buffer_load_dwordx4 v[208:211], v7, s[48:51], s65 offen offset:0 nt
    v_mfma_f32_16x16x32_bf16 v[36:39], v[8:11], v[216:219], v[36:39]
    v_and_b32_dpp v12, v40, v24 row_newbcast:11 row_mask:0xf bank_mask:0xf
    v_and_b32_dpp v13, v40, v25 row_newbcast:11 row_mask:0xf bank_mask:0xf
    v_and_b32_dpp v14, v40, v26 row_newbcast:11 row_mask:0xf bank_mask:0xf
    v_and_b32_dpp v15, v40, v27 row_newbcast:11 row_mask:0xf bank_mask:0xf
    s_waitcnt vmcnt(4)
    buffer_load_dwordx4 v[212:215], v7, s[48:51], s65 offen offset:1024 nt
    v_mfma_f32_16x16x32_bf16 v[36:39], v[12:15], v[220:223], v[36:39]
    s_sub_u32 s75, s75, 1
    s_cbranch_scc1 L_vend
    v_and_b32_dpp v8, v40, v24 row_newbcast:12 row_mask:0xf bank_mask:0xf
    v_and_b32_dpp v9, v40, v25 row_newbcast:12 row_mask:0xf bank_mask:0xf
    v_and_b32_dpp v10, v40, v26 row_newbcast:12 row_mask:0xf bank_mask:0xf
    v_and_b32_dpp v11, v40, v27 row_newbcast:12 row_mask:0xf bank_mask:0xf
    s_waitcnt vmcnt(4)
    buffer_load_dwordx4 v[216:219], v7, s[48:51], s65 offen offset:2048 nt
    v_mfma_f32_16x16x32_bf16 v[36:39], v[8:11], v[224:227], v[36:39]
    v_and_b32_dpp v12, v40, v24 row_newbcast:13 row_mask:0xf bank_mask:0xf
    v_and_b32_dpp v13, v40, v25 row_newbcast:13 row_mask:0xf bank_mask:0xf
    v_and_b32_dpp v14, v40, v26 row_newbcast:13 row_mask:0xf bank_mask:0xf
    v_and_b32_dpp v15, v40, v27 row_newbcast:13 row_mask:0xf bank_mask:0xf
    s_waitcnt vmcnt(4)
    buffer_load_dwordx4 v[220:223], v7, s[48:51], s65 offen offset:3072 nt
    s_addk_i32 s65, 0x4000
    v_mfma_f32_16x16x32_bf16 v[36:39], v[12:15], v[228:231], v[36:39]
    v_and_b32_dpp v8, v40, v24 row_newbcast:14 row_mask:0xf bank_mask:0xf
    v_and_b32_dpp v9, v40, v25 row_newbcast:14 row_mask:0xf bank_mask:0xf
    v_and_b32_dpp v10, v40, v26 row_newbcast:14 row_mask:0xf bank_mask:0xf
    v_and_b32_dpp v11, v40, v27 row_newbcast:14 row_mask:0xf bank_mask:0xf
    s_waitcnt vmcnt(4)
    buffer_load_dwordx4 v[224:227], v7, s[48:51], s65 offen offset:0 nt
    v_mfma_f32_16x16x32_bf16 v[36:39], v[8:11], v[232:235], v[36:39]
    v_and_b32_dpp v12, v40, v24 row_newbcast:15 row_mask:0xf bank_mask:0xf
    v_and_b32_dpp v13, v40, v25 row_newbcast:15 row_mask:0xf bank_mask:0xf
    v_and_b32_dpp v14, v40, v26 row_newbcast:15 row_mask:0xf bank_mask:0xf
    v_and_b32_dpp v15, v40, v27 row_newbcast:15 row_mask:0xf bank_mask:0xf
    s_waitcnt vmcnt(4)
    buffer_load_dwordx4 v[228:231], v7, s[48:51], s65 offen offset:1024 nt
    v_mfma_f32_16x16x32_bf16 v[36:39], v[12:15], v[236:239], v[36:39]
    s_sub_u32 s75, s75, 1
    s_cbranch_scc1 L_vend
    v_and_b32_dpp v8, v41, v24 row_newbcast:0 row_mask:0xf bank_mask:0xf
    v_and_b32_dpp v9, v41, v25 row_newbcast:0 row_mask:0xf bank_mask:0xf
    v_and_b32_dpp v10, v41, v26 row_newbcast:0 row_mask:0xf bank_mask:0xf
    v_and_b32_dpp v11, v41, v27 row_newbcast:0 row_mask:0xf bank_mask:0xf
    v_mov_b32 v40, v41
    v_mov_b32 v41, v42
    v_mov_b32 v42, v43
    v_mov_b32 v43, v44
    v_mov_b32 v44, v45
    v_mov_b32 v45, v46
    v_mov_b32 v46, v47
    v_mov_b32 v47, v48
    s_add_u32 s72, s72, 1
    s_sub_u32 s12, s72, 3
    s_cmp_le_u32 s12, 2
    s_cbranch_scc1 L_mlx
    s_branch L_vloop
L_vloop2:
    s_waitcnt vmcnt(5)
    buffer_load_dwordx4 v[232:235], v7, s[48:51], s65 offen offset:2048 nt
    v_mfma_f32_16x16x32_bf16 v[36:39], v[8:11], v[208:211], v[36:39]
    v_and_b32_dpp v12, v40, v24 row_newbcast:1 row_mask:0xf bank_mask:0xf
    v_and_b32_dpp v13, v40, v25 row_newbcast:1 row_mask:0xf bank_mask:0xf
    v_and_b32_dpp v14, v40, v26 row_newbcast:1 row_mask:0xf bank_mask:0xf
    v_and_b32_dpp v15, v40, v27 row_newbcast:1 row_mask:0xf bank_mask:0xf
    s_waitcnt vmcnt(5)
    buffer_load_dwordx4 v[236:239], v7, s[48:51], s65 offen offset:3072 nt
    s_addk_i32 s65, 0x4000
    v_mfma_f32_16x16x32_bf16 v[36:39], v[12:15], v[212:215], v[36:39]
    v_and_b32_dpp v8, v40, v24 row_newbcast:2 row_mask:0xf bank_mask:0xf
    v_and_b32_dpp v9, v40, v25 row_newbcast:2 row_mask:0xf bank_mask:0xf
    v_and_b32_dpp v10, v40, v26 row_newbcast:2 row_mask:0xf bank_mask:0xf
    v_and_b32_dpp v11, v40, v27 row_newbcast:2 row_mask:0xf bank_mask:0xf
    s_waitcnt vmcnt(5)
    buffer_load_dwordx4 v[208:211], v7, s[48:51], s65 offen offset:0 nt
    v_mfma_f32_16x16x32_bf16 v[36:39], v[8:11], v[216:219], v[36:39]
    v_and_b32_dpp v12, v40, v24 row_newbcast:3 row_mask:0xf bank_mask:0xf
    v_and_b32_dpp v13, v40, v25 row_newbcast:3 row_mask:0xf bank_mask:0xf
    v_and_b32_dpp v14, v40, v26 row_newbcast:3 row_mask:0xf bank_mask:0xf
    v_and_b32_dpp v15, v40, v27 row_newbcast:3 row_mask:0xf bank_mask:0xf
    s_waitcnt vmcnt(5)
    buffer_load_dwordx4 v[212:215], v7, s[48:51], s65 offen offset:1024 nt
    v_mfma_f32_16x16x32_bf16 v[36:39], v[12:15], v[220:223], v[36:39]
    s_sub_u32 s75, s75, 1
    s_cbranch_scc1 L_vend
    v_and_b32_dpp v8, v40, v24 row_newbcast:4 row_mask:0xf bank_mask:0xf
    v_and_b32_dpp v9, v40, v25 row_newbcast:4 row_mask:0xf bank_mask:0xf
    v_and_b32_dpp v10, v40, v26 row_newbcast:4 row_mask:0xf bank_mask:0xf
    v_and_b32_dpp v11, v40, v27 row_newbcast:4 row_mask:0xf bank_mask:0xf
    s_waitcnt vmcnt(5)
    buffer_load_dwordx4 v[216:219], v7, s[48:51], s65 offen offset:2048 nt
    v_mfma_f32_16x16x32_bf16 v[36:39], v[8:11], v[224:227], v[36:39]
    v_and_b32_dpp v12, v40, v24 row_newbcast:5 row_mask:0xf bank_mask:0xf
    v_and_b32_dpp v13, v40, v25 row_newbcast:5 row_mask:0xf bank_mask:0xf
    v_and_b32_dpp v14, v40, v26 row_newbcast:5 row_mask:0xf bank_mask:0xf
    v_and_b32_dpp v15, v40, v27 row_newbcast:5 row_mask:0xf bank_mask:0xf
    s_waitcnt vmcnt(5)
    buffer_load_dwordx4 v[220:223], v7, s[48:51], s65 offen offset:3072 nt
    s_addk_i32 s65, 0x4000
    v_mfma_f32_16x16x32_bf16 v[36:39], v[12:15], v[228:231], v[36:39]
    v_and_b32_dpp v8, v40, v24 row_newbcast:6 row_mask:0xf bank_mask:0xf
    v_and_b32_dpp v9, v40, v25 row_newbcast:6 row_mask:0xf bank_mask:0xf
    v_and_b32_dpp v10, v40, v26 row_newbcast:6 row_mask:0xf bank_mask:0xf
    v_and_b32_dpp v11, v40, v27 row_newbcast:6 row_mask:0xf bank_mask:0xf
    s_waitcnt vmcnt(5)
    buffer_load_dwordx4 v[224:227], v7, s[48:51], s65 offen offset:0 nt
    v_mfma_f32_16x16x32_bf16 v[36:39], v[8:11], v[232:235], v[36:39]
    v_and_b32_dpp v12, v40, v24 row_newbcast:7 row_mask:0xf bank_mask:0xf
    v_and_b32_dpp v13, v40, v25 row_newbcast:7 row_mask:0xf bank_mask:0xf
    v_and_b32_dpp v14, v40, v26 row_newbcast:7 row_mask:0xf bank_mask:0xf
    v_and_b32_dpp v15, v40, v27 row_newbcast:7 row_mask:0xf bank_mask:0xf
    s_waitcnt vmcnt(5)
    buffer_load_dwordx4 v[228:231], v7, s[48:51], s65 offen offset:1024 nt
    v_mfma_f32_16x16x32_bf16 v[36:39], v[12:15], v[236:239], v[36:39]
    s_sub_u32 s75, s75, 1
    s_cbranch_scc1 L_vend
    v_and_b32_dpp v8, v40, v24 row_newbcast:8 row_mask:0xf bank_mask:0xf
    v_and_b32_dpp v9, v40, v25 row_newbcast:8 row_mask:0xf bank_mask:0xf
    v_and_b32_dpp v10, v40, v26 row_newbcast:8 row_mask:0xf bank_mask:0xf
    v_and_b32_dpp v11, v40, v27 row_newbcast:8 row_mask:0xf bank_mask:0xf
    s_waitcnt vmcnt(5)
    buffer_load_dwordx4 v[232:235], v7, s[48:51], s65 offen offset:2048 nt
    v_mfma_f32_16x16x32_bf16 v[36:39], v[8:11], v[208:211], v[36:39]
    v_and_b32_dpp v12, v40, v24 row_newbcast:9 row_mask:0xf bank_mask:0xf
    v_and_b32_dpp v13, v40, v25 row_newbcast:9 row_mask:0xf bank_mask:0xf
    v_and_b32_dpp v14, v40, v26 row_newbcast:9 row_mask:0xf bank_mask:0xf
    v_and_b32_dpp v15, v40, v27 row_newbcast:9 row_mask:0xf bank_mask:0xf
    s_waitcnt vmcnt(5)
    buffer_load_dwordx4 v[236:239], v7, s[48:51], s65 offen offset:3072 nt
    s_addk_i32 s65, 0x4000
    v_mfma_f32_16x16x32_bf16 v[36:39], v[12:15], v[212:215], v[36:39]
    v_and_b32_dpp v8, v40, v24 row_newbcast:10 row_mask:0xf bank_mask:0xf
    v_and_b32_dpp v9, v40, v25 row_newbcast:10 row_mask:0xf bank_mask:0xf
    v_and_b32_dpp v10, v40, v26 row_newbcast:10 row_mask:0xf bank_mask:0xf
    v_and_b32_dpp v11, v40, v27 row_newbcast:10 row_mask:0xf bank_mask:0xf
    s_waitcnt vmcnt(5)
    buffer_load_dwordx4 v[208:211], v7, s[48:51], s65 offen offset:0 nt
    v_mfma_f32_16x16x32_bf16 v[36:39], v[8:11], v[216:219], v[36:39]
    v_and_b32_dpp v12, v40, v24 row_newbcast:11 row_mask:0xf bank_mask:0xf
    v_and_b32_dpp v13, v40, v25 row_newbcast:11 row_mask:0xf bank_mask:0xf
    v_and_b32_dpp v14, v40, v26 row_newbcast:11 row_mask:0xf bank_mask:0xf
    v_and_b32_dpp v15, v40, v27 row_newbcast:11 row_mask:0xf bank_mask:0xf
    s_waitcnt vmcnt(5)
    buffer_load_dwordx4 v[212:215], v7, s[48:51], s65 offen offset:1024 nt
    v_mfma_f32_16x16x32_bf16 v[36:39], v[12:15], v[220:223], v[36:39]
    s_sub_u32 s75, s75, 1
    s_cbranch_scc1 L_vend
    v_and_b32_dpp v8, v40, v24 row_newbcast:12 row_mask:0xf bank_mask:0xf
    v_and_b32_dpp v9, v40, v25 row_newbcast:12 row_mask:0xf bank_mask:0xf
    v_and_b32_dpp v10, v40, v26 row_newbcast:12 row_mask:0xf bank_mask:0xf
    v_and_b32_dpp v11, v40, v27 row_newbcast:12 row_mask:0xf bank_mask:0xf
    s_waitcnt vmcnt(5)
    buffer_load_dwordx4 v[216:219], v7, s[48:51], s65 offen offset:2048 nt
    v_mfma_f32_16x16x32_bf16 v[36:39], v[8:11], v[224:227], v[36:39]
    v_and_b32_dpp v12, v40, v24 row_newbcast:13 row_mask:0xf bank_mask:0xf
    v_and_b32_dpp v13, v40, v25 row_newbcast:13 row_mask:0xf bank_mask:0xf
    v_and_b32_dpp v14, v40, v26 row_newbcast:13 row_mask:0xf bank_mask:0xf
    v_and_b32_dpp v15, v40, v27 row_newbcast:13 row_mask:0xf bank_mask:0xf
    s_waitcnt vmcnt(5)
    buffer_load_dwordx4 v[220:223], v7, s[48:51], s65 offen offset:3072 nt
    s_addk_i32 s65, 0x4000
    v_mfma_f32_16x16x32_bf16 v[36:39], v[12:15], v[228:231], v[36:39]
    v_and_b32_dpp v8, v40, v24 row_newbcast:14 row_mask:0xf bank_mask:0xf
    v_and_b32_dpp v9, v40, v25 row_newbcast:14 row_mask:0xf bank_mask:0xf
    v_and_b32_dpp v10, v40, v26 row_newbcast:14 row_mask:0xf bank_mask:0xf
    v_and_b32_dpp v11, v40, v27 row_newbcast:14 row_mask:0xf bank_mask:0xf
    s_waitcnt vmcnt(5)
    buffer_load_dwordx4 v[224:227], v7, s[48:51], s65 offen offset:0 nt
    v_mfma_f32_16x16x32_bf16 v[36:39], v[8:11], v[232:235], v[36:39]
    v_and_b32_dpp v12, v40, v24 row_newbcast:15 row_mask:0xf bank_mask:0xf
    v_and_b32_dpp v13, v40, v25 row_newbcast:15 row_mask:0xf bank_mask:0xf
    v_and_b32_dpp v14, v40, v26 row_newbcast:15 row_mask:0xf bank_mask:0xf
    v_and_b32_dpp v15, v40, v27 row_newbcast:15 row_mask:0xf bank_mask:0xf
    s_waitcnt vmcnt(5)
    buffer_load_dwordx4 v[228:231], v7, s[48:51], s65 offen offset:1024 nt
    v_mfma_f32_16x16x32_bf16 v[36:39], v[12:15], v[236:239], v[36:39]
    s_sub_u32 s75, s75, 1
    s_cbranch_scc1 L_vend
    v_and_b32_dpp v8, v41, v24 row_newbcast:0 row_mask:0xf bank_mask:0xf
    v_and_b32_dpp v9, v41, v25 row_newbcast:0 row_mask:0xf bank_mask:0xf
    v_and_b32_dpp v10, v41, v26 row_newbcast:0 row_mask:0xf bank_mask:0xf
    v_and_b32_dpp v11, v41, v27 row_newbcast:0 row_mask:0xf bank_mask:0xf
    v_mov_b32 v40, v41
    v_mov_b32 v41, v42
    v_mov_b32 v42, v43
    v_mov_b32 v43, v44
    v_mov_b32 v44, v45
    v_mov_b32 v45, v46
    v_mov_b32 v46, v47
    v_mov_b32 v47, v48
    s_branch L_vloop2
L_vend:
    s_nop 5
    v_mul_f32 v36, v30, v36
    v_mul_f32 v37, v30, v37
    v_mul_f32 v38, v30, v38
    v_mul_f32 v39, v30, v39
    v_cvt_pk_bf16_f32 v32, v36, v37
    v_cvt_pk_bf16_f32 v33, v38, v39
    ds_write_b64 v28, v[32:33]
    s_cmp_eq_u32 s98, 0
    s_waitcnt lgkmcnt(0)
    s_cbranch_scc1 L_tail
    s_barrier
L_tail:
    s_cmp_eq_u32 s76, 4
    s_cbranch_scc1 L_stepB
    s_cmp_lg_u32 s76, 1
    s_cbranch_scc1 L_fin
    v_lshlrev_b32 v9, 9, v3
    v_lshl_add_u32 v9, v4, 6, v9
    v_and_b32 v11, 1, v1
    v_lshl_add_u32 v9, v11, 3, v9
    v_lshrrev_b32 v10, 1, v5
    v_lshl_add_u32 v9, v10, 15, v9
    s_lshl_b32 s12, s3, 4
    s_add_u32 s14, s12, 32768
    v_add_u32 v9, s14, v9
    ds_read_b64_tr_b16 v[64:65], v9 offset:0
    ds_read_b64_tr_b16 v[66:67], v9 offset:256
    ds_read_b64_tr_b16 v[68:69], v9 offset:2048
    ds_read_b64_tr_b16 v[70:71], v9 offset:2304
    ds_read_b64_tr_b16 v[72:73], v9 offset:4096
    ds_read_b64_tr_b16 v[74:75], v9 offset:4352
    ds_read_b64_tr_b16 v[76:77], v9 offset:6144
    ds_read_b64_tr_b16 v[78:79], v9 offset:6400
    ds_read_b64_tr_b16 v[80:81], v9 offset:8192
    ds_read_b64_tr_b16 v[82:83], v9 offset:8448
    ds_read_b64_tr_b16 v[84:85], v9 offset:10240
    ds_read_b64_tr_b16 v[86:87], v9 offset:10496
    ds_read_b64_tr_b16 v[88:89], v9 offset:12288
    ds_read_b64_tr_b16 v[90:91], v9 offset:12544
    ds_read_b64_tr_b16 v[92:93], v9 offset:14336
    ds_read_b64_tr_b16 v[94:95], v9 offset:14592
    ds_read_b64_tr_b16 v[96:97], v9 offset:16384
    ds_read_b64_tr_b16 v[98:99], v9 offset:16640
    ds_read_b64_tr_b16 v[100:101], v9 offset:18432
    ds_read_b64_tr_b16 v[102:103], v9 offset:18688
    ds_read_b64_tr_b16 v[104:105], v9 offset:20480
    ds_read_b64_tr_b16 v[106:107], v9 offset:20736
    ds_read_b64_tr_b16 v[108:109], v9 offset:22528
    ds_read_b64_tr_b16 v[110:111], v9 offset:22784
    ds_read_b64_tr_b16 v[112:113], v9 offset:24576
    ds_read_b64_tr_b16 v[114:115], v9 offset:24832
    ds_read_b64_tr_b16 v[116:117], v9 offset:26624
    ds_read_b64_tr_b16 v[118:119], v9 offset:26880
    ds_read_b64_tr_b16 v[120:121], v9 offset:28672
    ds_read_b64_tr_b16 v[122:123], v9 offset:28928
    ds_read_b64_tr_b16 v[124:125], v9 offset:30720
    ds_read_b64_tr_b16 v[126:127], v9 offset:30976
    v_mov_b32 v57, s10
    v_lshlrev_b32 v12, 10, v11
    v_lshl_add_u32 v12, v3, 4, v12
    v_add_u32 v12, 150752, v12
    v_lshlrev_b32 v13, 6, v11
    v_and_b32 v14, 1, v3
    v_lshl_add_u32 v13, v14, 3, v13
    v_lshrrev_b32 v14, 1, v3
    v_lshl_add_u32 v13, v14, 2, v13
    s_add_u32 s12, s12, 148480
    v_add_u32 v13, s12, v13
    v_lshlrev_b32 v14, 2, v1
    v_add_u32 v14, 149728, v14
    s_min_u32 s14, s98, 2
    v_cmp_gt_u32 vcc, s14, v2
    s_nop 1
    v_cndmask_b32 v13, v14, v13, vcc
    s_mov_b32 s68, 0x3727c5ac
    s_mov_b32 s69, 0x3fb8aa3b
    s_mov_b32 s70, s98
    v_mov_b32 v15, 148608
    s_lshl_b32 s12, s3, 2
    s_add_u32 s12, s12, 148608
    s_cmp_eq_u32 s98, 0
    s_cselect_b32 s12, 149728, s12
    v_mov_b32 v56, s12
    s_sub_u32 s13, s3, 1
    s_cmp_ge_u32 s13, 2
    s_cbranch_scc1 L_c_h2s
    s_lshl_b32 s14, s13, 11
    s_add_u32 s14, s14, 8192
    s_add_u32 s15, s14, 4096
    v_lshlrev_b32 v8, 5, v1
L_c_sbcb:
    buffer_load_dwordx4 v[40:43], v8, s[52:55], s14 offen offset:0 sc1
    buffer_load_dwordx4 v[44:47], v8, s[52:55], s14 offen offset:16 sc1
    buffer_load_dwordx4 v[48:51], v8, s[52:55], s15 offen offset:0 sc1
    buffer_load_dwordx4 v[52:55], v8, s[52:55], s15 offen offset:16 sc1
    s_waitcnt vmcnt(0)
    v_cmp_ne_u32 vcc, v57, v42
    v_cmp_ne_u32 s[66:67], v57, v43
    s_or_b64 vcc, vcc, s[66:67]
    v_cmp_ne_u32 s[66:67], v57, v46
    s_or_b64 vcc, vcc, s[66:67]
    v_cmp_ne_u32 s[66:67], v57, v47
    s_or_b64 vcc, vcc, s[66:67]
    v_cmp_ne_u32 s[66:67], v57, v50
    s_or_b64 vcc, vcc, s[66:67]
    v_cmp_ne_u32 s[66:67], v57, v51
    s_or_b64 vcc, vcc, s[66:67]
    v_cmp_ne_u32 s[66:67], v57, v54
    s_or_b64 vcc, vcc, s[66:67]
    v_cmp_ne_u32 s[66:67], v57, v55
    s_or_b64 vcc, vcc, s[66:67]
    s_sub_u32 s70, s70, 1
    s_cbranch_scc1 L_to_3
    s_cbranch_vccnz L_c_sbcb
L_out_2:
    v_lshlrev_b32 v16, 16, v40
    v_and_b32 v17, 0xffff0000, v40
    v_lshlrev_b32 v18, 16, v41
    v_and_b32 v19, 0xffff0000, v41
    v_lshlrev_b32 v20, 16, v44
    v_and_b32 v21, 0xffff0000, v44
    v_lshlrev_b32 v22, 16, v45
    v_and_b32 v23, 0xffff0000, v45
    v_lshlrev_b32 v24, 16, v48
    v_and_b32 v25, 0xffff0000, v48
    v_lshlrev_b32 v26, 16, v49
    v_and_b32 v27, 0xffff0000, v49
    v_lshlrev_b32 v28, 16, v52
    v_and_b32 v29, 0xffff0000, v52
    v_lshlrev_b32 v30, 16, v53
    v_and_b32 v31, 0xffff0000, v53
    v_add_f32 v24, 1.0, v24
    v_add_f32 v25, 1.0, v25
    v_add_f32 v26, 1.0, v26
    v_add_f32 v27, 1.0, v27
    v_add_f32 v28, 1.0, v28
    v_add_f32 v29, 1.0, v29
    v_add_f32 v30, 1.0, v30
    v_add_f32 v31, 1.0, v31
    v_cvt_pk_bf16_f32 v40, v24, v25
    v_cvt_pk_bf16_f32 v41, v26, v27
    v_cvt_pk_bf16_f32 v42, v28, v29
    v_cvt_pk_bf16_f32 v43, v30, v31
    v_lshlrev_b32 v24, 16, v40
    v_and_b32 v25, 0xffff0000, v40
    v_lshlrev_b32 v26, 16, v41
    v_and_b32 v27, 0xffff0000, v41
    v_lshlrev_b32 v28, 16, v42
    v_and_b32 v29, 0xffff0000, v42
    v_lshlrev_b32 v30, 16, v43
    v_and_b32 v31, 0xffff0000, v43
    s_lshl_b32 s14, s13, 10
    s_add_u32 s15, s14, 150752
    s_cmp_eq_u32 s98, 0
    s_cselect_b32 s15, 149728, s15
    s_lshl_b32 s14, s13, 12
    s_add_u32 s14, s14, 1572864
    s_lshr_b32 s12, s4, 1
    s_lshl_b32 s12, s12, 13
    s_andn2_b32 s12, s12, 0x80000000
    s_add_u32 s14, s14, s12
    v_lshlrev_b32 v8, 4, v1
    v_add_u32 v10, s15, v8
    v_lshrrev_b32 v8, 1, v1
    v_lshlrev_b32 v8, 7, v8
    v_lshl_add_u32 v8, v11, 5, v8
    s_mov_b32 s12, 0x05040100
    s_waitcnt lgkmcnt(0)
    s_mov_b32 s70, s98
L_c_x1:
    buffer_load_dwordx4 v[192:195], v8, s[52:55], s14 offen sc1
    buffer_load_dwordx4 v[196:199], v8, s[52:55], s14 offen offset:16 sc1
    s_waitcnt vmcnt(0)
    v_perm_b32 v40, v193, v192, s12
    v_perm_b32 v41, v195, v194, s12
    v_perm_b32 v42, v197, v196, s12
    v_perm_b32 v43, v199, v198, s12
    v_sad_u8 v44, v40, v57, 0
    v_and_b32 v32, 0xffff0000, v192
    v_and_b32 v33, 0xffff0000, v193
    v_sad_u8 v44, v41, v57, v44
    v_and_b32 v34, 0xffff0000, v194
    v_and_b32 v35, 0xffff0000, v195
    v_sad_u8 v44, v42, v57, v44
    v_and_b32 v36, 0xffff0000, v196
    v_and_b32 v37, 0xffff0000, v197
    v_sad_u8 v44, v43, v57, v44
    v_and_b32 v38, 0xffff0000, v198
    v_and_b32 v39, 0xffff0000, v199
    v_cmp_ne_u32 vcc, 0, v44
    s_sub_u32 s70, s70, 1
    s_cbranch_scc1 L_to_5
    s_cbranch_vccnz L_c_x1
L_out_4:
    v_readfirstlane_b32 s71, v32
    s_nop 1
    v_subrev_f32 v44, s71, v32
    v_subrev_f32 v45, s71, v33
    v_subrev_f32 v46, s71, v34
    v_subrev_f32 v47, s71, v35
    v_subrev_f32 v48, s71, v36
    v_subrev_f32 v49, s71, v37
    v_subrev_f32 v50, s71, v38
    v_subrev_f32 v51, s71, v39
    v_add_f32 v40, v44, v45
    v_mul_f32 v41, v44, v44
    v_add_f32 v42, v46, v47
    v_mul_f32 v43, v45, v45
    v_add_f32 v52, v48, v49
    v_fmac_f32 v41, v46, v46
    v_add_f32 v53, v50, v51
    v_fmac_f32 v43, v47, v47
    v_add_f32 v40, v40, v42
    v_fmac_f32 v41, v48, v48
    v_add_f32 v52, v52, v53
    v_fmac_f32 v43, v49, v49
    v_fmac_f32 v41, v50, v50
    v_fmac_f32 v43, v51, v51
    v_add_f32 v40, v40, v52
    v_add_f32 v41, v41, v43
    s_nop 0
    v_add_f32_dpp v40, v40, v40 row_ror:8 row_mask:0xf bank_mask:0xf
    v_add_f32_dpp v41, v41, v41 row_ror:8 row_mask:0xf bank_mask:0xf
    s_nop 0
    v_add_f32_dpp v40, v40, v40 row_ror:4 row_mask:0xf bank_mask:0xf
    v_add_f32_dpp v41, v41, v41 row_ror:4 row_mask:0xf bank_mask:0xf
    s_nop 0
    v_add_f32_dpp v40, v40, v40 row_ror:2 row_mask:0xf bank_mask:0xf
    v_add_f32_dpp v41, v41, v41 row_ror:2 row_mask:0xf bank_mask:0xf
    s_nop 0
    v_add_f32_dpp v40, v40, v40 row_ror:1 row_mask:0xf bank_mask:0xf
    v_add_f32_dpp v41, v41, v41 row_ror:1 row_mask:0xf bank_mask:0xf
    s_nop 0
    v_add_f32_dpp v40, v40, v40 row_bcast:15 row_mask:0xa bank_mask:0xf
    v_add_f32_dpp v41, v41, v41 row_bcast:15 row_mask:0xa bank_mask:0xf
    s_nop 0
    v_add_f32_dpp v40, v40, v40 row_bcast:31 row_mask:0xc bank_mask:0xf
    v_add_f32_dpp v41, v41, v41 row_bcast:31 row_mask:0xc bank_mask:0xf
    v_readlane_b32 s72, v40, 63
    v_readlane_b32 s73, v41, 63
    v_mov_b32 v42, 0x3b000000
    v_mul_f32 v40, s72, v42
    v_mul_f32 v41, s73, v42
    v_add_f32 v43, s71, v40
    v_fma_f32 v41, -v40, v40, v41
    v_cvt_pk_bf16_f32 v43, v43, v43
    v_max_f32 v41, 0, v41
    v_and_b32 v43, 0xffff0000, v43
    v_cvt_pk_bf16_f32 v41, v41, v41
    v_sub_f32 v32, v32, v43
    v_and_b32 v41, 0xffff0000, v41
    v_sub_f32 v33, v33, v43
    v_add_f32 v41, s68, v41
    v_sub_f32 v34, v34, v43
    v_cvt_pk_bf16_f32 v41, v41, v41
    v_sub_f32 v35, v35, v43
    v_and_b32 v41, 0xffff0000, v41
    v_sub_f32 v36, v36, v43
    v_sqrt_f32 v41, v41
    v_sub_f32 v37, v37, v43
    v_sub_f32 v38, v38, v43
    v_cvt_pk_bf16_f32 v41, v41, v41
    v_sub_f32 v39, v39, v43
    v_and_b32 v41, 0xffff0000, v41
    v_mul_f32 v32, v32, v24
    v_mul_f32 v33, v33, v25
    v_mul_f32 v34, v34, v26
    v_mul_f32 v35, v35, v27
    v_rcp_f32 v41, v41
    v_mul_f32 v36, v36, v28
    v_mul_f32 v37, v37, v29
    v_mul_f32 v38, v38, v30
    v_mul_f32 v39, v39, v31
    v_fma_f32 v32, v32, v41, v16
    v_fma_f32 v33, v33, v41, v17
    v_fma_f32 v34, v34, v41, v18
    v_fma_f32 v35, v35, v41, v19
    v_fma_f32 v36, v36, v41, v20
    v_fma_f32 v37, v37, v41, v21
    v_fma_f32 v38, v38, v41, v22
    v_fma_f32 v39, v39, v41, v23
    v_cvt_pk_bf16_f32 v44, v32, v33
    v_cvt_pk_bf16_f32 v45, v34, v35
    v_cvt_pk_bf16_f32 v46, v36, v37
    v_cvt_pk_bf16_f32 v47, v38, v39
    ds_write_b128 v10, v[44:47]
    ds_write_b32 v56, v57
    s_mov_b32 s70, s98
    s_branch L_c_h2
L_c_h2s:
    s_sleep 1
L_c_h2:
    ds_read2_b32 v[44:45], v15 offset0:1 offset1:2
    s_waitcnt lgkmcnt(0)
    v_cmp_ne_u32 vcc, v57, v44
    v_cmp_ne_u32 s[66:67], v57, v45
    s_or_b64 vcc, vcc, s[66:67]
    s_sub_u32 s70, s70, 1
    s_cbranch_scc1 L_to_7
    s_cbranch_vccnz L_c_h2s
L_out_6:
    ds_read_b128 v[128:131], v12 offset:0
    ds_read_b128 v[132:135], v12 offset:64
    ds_read_b128 v[136:139], v12 offset:128
    ds_read_b128 v[140:143], v12 offset:192
    ds_read_b128 v[144:147], v12 offset:256
    ds_read_b128 v[148:151], v12 offset:320
    ds_read_b128 v[152:155], v12 offset:384
    ds_read_b128 v[156:159], v12 offset:448
    ds_read_b128 v[160:163], v12 offset:512
    ds_read_b128 v[164:167], v12 offset:576
    ds_read_b128 v[168:171], v12 offset:640
    ds_read_b128 v[172:175], v12 offset:704
    ds_read_b128 v[176:179], v12 offset:768
    ds_read_b128 v[180:183], v12 offset:832
    ds_read_b128 v[184:187], v12 offset:896
    ds_read_b128 v[188:191], v12 offset:960
    s_waitcnt lgkmcnt(15)
    v_mfma_f32_16x16x32_bf16 v[40:43], v[64:67], v[128:131], 0
    s_waitcnt lgkmcnt(14)
    v_mfma_f32_16x16x32_bf16 v[40:43], v[68:71], v[132:135], v[40:43]
    s_waitcnt lgkmcnt(13)
    v_mfma_f32_16x16x32_bf16 v[40:43], v[72:75], v[136:139], v[40:43]
    s_waitcnt lgkmcnt(12)
    v_mfma_f32_16x16x32_bf16 v[40:43], v[76:79], v[140:143], v[40:43]
    s_waitcnt lgkmcnt(11)
    v_mfma_f32_16x16x32_bf16 v[40:43], v[80:83], v[144:147], v[40:43]
    s_waitcnt lgkmcnt(10)
    v_mfma_f32_16x16x32_bf16 v[40:43], v[84:87], v[148:151], v[40:43]
    s_waitcnt lgkmcnt(9)
    v_mfma_f32_16x16x32_bf16 v[40:43], v[88:91], v[152:155], v[40:43]
    s_waitcnt lgkmcnt(8)
    v_mfma_f32_16x16x32_bf16 v[40:43], v[92:95], v[156:159], v[40:43]
    s_waitcnt lgkmcnt(7)
    v_mfma_f32_16x16x32_bf16 v[40:43], v[96:99], v[160:163], v[40:43]
    s_waitcnt lgkmcnt(6)
    v_mfma_f32_16x16x32_bf16 v[40:43], v[100:103], v[164:167], v[40:43]
    s_waitcnt lgkmcnt(5)
    v_mfma_f32_16x16x32_bf16 v[40:43], v[104:107], v[168:171], v[40:43]
    s_waitcnt lgkmcnt(4)
    v_mfma_f32_16x16x32_bf16 v[40:43], v[108:111], v[172:175], v[40:43]
    s_waitcnt lgkmcnt(3)
    v_mfma_f32_16x16x32_bf16 v[40:43], v[112:115], v[176:179], v[40:43]
    s_waitcnt lgkmcnt(2)
    v_mfma_f32_16x16x32_bf16 v[40:43], v[116:119], v[180:183], v[40:43]
    s_waitcnt lgkmcnt(1)
    v_mfma_f32_16x16x32_bf16 v[40:43], v[120:123], v[184:187], v[40:43]
    s_waitcnt lgkmcnt(0)
    v_mfma_f32_16x16x32_bf16 v[40:43], v[124:127], v[188:191], v[40:43]
    s_nop 7
    v_permlane32_swap_b32 v40, v42
    v_permlane32_swap_b32 v41, v43
    v_cvt_pk_bf16_f32 v44, v40, v41
    v_cvt_pk_bf16_f32 v45, v42, v43
    v_lshlrev_b32 v40, 16, v44
    v_and_b32 v41, 0xffff0000, v44
    v_lshlrev_b32 v42, 16, v45
    v_and_b32 v43, 0xffff0000, v45
    v_mul_f32 v44, s69, v40
    v_mul_f32 v45, s69, v41
    v_exp_f32 v44, -v44
    v_exp_f32 v45, -v45
    v_add_f32 v44, 1.0, v44
    v_add_f32 v45, 1.0, v45
    v_rcp_f32 v44, v44
    v_rcp_f32 v45, v45
    v_mul_f32 v40, v40, v44
    v_mul_f32 v41, v41, v45
    v_cvt_pk_bf16_f32 v44, v40, v41
    v_lshlrev_b32 v40, 16, v44
    v_and_b32 v41, 0xffff0000, v44
    v_mul_f32 v40, v40, v42
    v_mul_f32 v41, v41, v43
    v_cvt_pk_bf16_f32 v44, v40, v41
    ds_write_b32 v13, v44
    ds_write_b32 v56, v57 offset:16
L_fin:
    s_cmp_eq_u32 s98, 0
    s_cbranch_scc1 L_dryret
    s_endpgm
L_stepB:
    s_cmp_lg_u32 s3, 0
    s_cbranch_scc1 L_fin
    s_mov_b32 s56, s44
    s_mov_b32 s57, s45
    s_mov_b32 s58, 0x800
    s_mov_b32 s59, 0x20000
    s_mov_b32 s60, s46
    s_mov_b32 s61, s47
    s_mov_b32 s62, 0x800
    s_mov_b32 s63, 0x20000
    s_lshl_b32 s14, s77, 6
    s_add_u32 s14, s14, 4096
    s_add_u32 s13, s14, 12288
    s_lshl_b32 s15, s77, 5
    s_lshl_b32 s72, s77, 13
    s_add_u32 s72, s72, 458752
    s_add_u32 s75, s72, 4096
    s_lshl_b32 s73, s77, 7
    s_add_u32 s73, s73, 1572864
    s_mul_i32 s74, s77, 3072
    s_add_u32 s74, s74, 983040
    v_lshlrev_b32 v8, 4, v5
    v_lshlrev_b32 v9, 4, v1
    v_lshlrev_b32 v12, 3, v5
    v_lshl_add_u32 v13, v3, 1, v12
    v_mov_b32 v10, 0x7ff00000
    v_cmp_gt_u32 vcc, 44, v1
    s_nop 1
    v_cndmask_b32 v14, v10, v9, vcc
    v_cmp_gt_u32 vcc, 4, v1
    s_nop 1
    v_cndmask_b32 v12, v10, v12, vcc
    v_cmp_eq_u32 vcc, 0, v1
    s_nop 1
    v_cndmask_b32 v10, v10, v1, vcc
    v_mov_b32 v11, s10
    v_and_b32 v15, 1, v3
    v_lshlrev_b32 v15, 4, v15
    v_sub_u32 v15, 16, v15
    s_mov_b32 s12, 0x03020706
    s_mov_b32 s68, 0x0c0c0400
    v_and_b32 v38, 0xffff, v11
    v_lshrrev_b32 v39, 16, v11
    v_cmp_gt_u32 vcc, 44, v1
    s_nop 1
    v_cndmask_b32 v40, 0, v38, vcc
    v_cndmask_b32 v41, 0, v39, vcc
    v_mov_b32 v42, 0xffff0000
    v_cmp_eq_u32 vcc, 16, v15
    s_nop 1
    v_cndmask_b32 v43, v39, v38, vcc
    v_or_b32 v12, s99, v12
    v_or_b32 v10, s99, v10
    v_lshlrev_b32 v44, 13, v4
    v_lshl_add_u32 v44, v5, 4, v44
    v_mov_b32 v45, 0x7ff00000
    v_cmp_gt_u32 vcc, 16, v1
    s_nop 1
    v_cndmask_b32 v44, v45, v44, vcc
    v_or_b32 v44, s99, v44
    s_mov_b32 s70, s98
    buffer_load_ushort v16, v13, s[56:59], s15 offen
L_b_ga:
    buffer_load_dwordx4 v[20:23], v8, s[52:55], s14 offen sc1
    buffer_load_dwordx4 v[24:27], v8, s[52:55], s13 offen sc1
    s_waitcnt vmcnt(0)
    v_cmp_ne_u32 vcc, v11, v22
    v_cmp_ne_u32 s[66:67], v11, v23
    s_or_b64 vcc, vcc, s[66:67]
    v_cmp_ne_u32 s[66:67], v11, v26
    s_or_b64 vcc, vcc, s[66:67]
    v_cmp_ne_u32 s[66:67], v11, v27
    s_or_b64 vcc, vcc, s[66:67]
    s_sub_u32 s70, s70, 1
    s_cbranch_scc1 L_to_9
    s_cbranch_vccnz L_b_ga
L_out_8:
    v_cmp_gt_u32 vcc, 32, v1
    s_nop 1
    v_cndmask_b32 v17, v21, v20, vcc
    v_cndmask_b32 v18, v25, v24, vcc
    v_lshlrev_b32 v17, v15, v17
    v_lshlrev_b32 v18, v15, v18
    v_and_b32 v17, 0xffff0000, v17
    v_and_b32 v18, 0xffff0000, v18
    v_lshlrev_b32 v16, 16, v16
    s_mov_b32 s70, s98
L_b_y:
    buffer_load_dwordx4 v[64:67], v9, s[52:55], s72 offen offset:0 sc1
    buffer_load_dwordx4 v[68:71], v9, s[52:55], s72 offen offset:1024 sc1
    buffer_load_dwordx4 v[72:75], v9, s[52:55], s72 offen offset:2048 sc1
    buffer_load_dwordx4 v[76:79], v9, s[52:55], s72 offen offset:3072 sc1
    buffer_load_dwordx4 v[80:83], v9, s[52:55], s75 offen offset:0 sc1
    buffer_load_dwordx4 v[84:87], v9, s[52:55], s75 offen offset:1024 sc1
    buffer_load_dwordx4 v[88:91], v9, s[52:55], s75 offen offset:2048 sc1
    buffer_load_dwordx4 v[92:95], v9, s[52:55], s75 offen offset:3072 sc1
    s_sleep 6
L_b_y_l:
    buffer_load_dwordx4 v[128:131], v9, s[52:55], s72 offen offset:0 sc1
    buffer_load_dwordx4 v[132:135], v9, s[52:55], s72 offen offset:1024 sc1
    buffer_load_dwordx4 v[136:139], v9, s[52:55], s72 offen offset:2048 sc1
    buffer_load_dwordx4 v[140:143], v9, s[52:55], s72 offen offset:3072 sc1
    buffer_load_dwordx4 v[144:147], v9, s[52:55], s75 offen offset:0 sc1
    buffer_load_dwordx4 v[148:151], v9, s[52:55], s75 offen offset:1024 sc1
    buffer_load_dwordx4 v[152:155], v9, s[52:55], s75 offen offset:2048 sc1
    buffer_load_dwordx4 v[156:159], v9, s[52:55], s75 offen offset:3072 sc1
    s_waitcnt vmcnt(15)
    v_perm_b32 v36, v65, v64, s68
    v_perm_b32 v37, v67, v66, s68
    v_sad_u8 v28, v36, v38, 0
    v_sad_u8 v28, v37, v39, v28
    s_waitcnt vmcnt(14)
    v_perm_b32 v36, v69, v68, s68
    v_perm_b32 v37, v71, v70, s68
    v_add_f32 v32, v64, v68
    v_add_f32 v33, v65, v69
    v_sad_u8 v28, v36, v38, v28
    v_add_f32 v34, v66, v70
    v_add_f32 v35, v67, v71
    v_sad_u8 v28, v37, v39, v28
    s_waitcnt vmcnt(13)
    v_perm_b32 v36, v73, v72, s68
    v_perm_b32 v37, v75, v74, s68
    v_add_f32 v32, v32, v72
    v_add_f32 v33, v33, v73
    v_sad_u8 v28, v36, v38, v28
    v_add_f32 v34, v34, v74
    v_add_f32 v35, v35, v75
    v_sad_u8 v28, v37, v39, v28
    s_waitcnt vmcnt(12)
    v_perm_b32 v36, v77, v76, s68
    v_perm_b32 v37, v79, v78, s68
    v_add_f32 v32, v32, v76
    v_add_f32 v33, v33, v77
    v_sad_u8 v28, v36, v38, v28
    v_add_f32 v34, v34, v78
    v_add_f32 v35, v35, v79
    v_sad_u8 v28, v37, v39, v28
    s_waitcnt vmcnt(11)
    v_perm_b32 v36, v81, v80, s68
    v_perm_b32 v37, v83, v82, s68
    v_add_f32 v32, v32, v80
    v_add_f32 v33, v33, v81
    v_sad_u8 v28, v36, v38, v28
    v_add_f32 v34, v34, v82
    v_add_f32 v35, v35, v83
    v_sad_u8 v28, v37, v39, v28
    s_waitcnt vmcnt(10)
    v_perm_b32 v36, v85, v84, s68
    v_perm_b32 v37, v87, v86, s68
    v_add_f32 v32, v32, v84
    v_add_f32 v33, v33, v85
    v_sad_u8 v28, v36, v38, v28
    v_add_f32 v34, v34, v86
    v_add_f32 v35, v35, v87
    v_sad_u8 v28, v37, v39, v28
    s_waitcnt vmcnt(9)
    v_perm_b32 v36, v89, v88, s68
    v_perm_b32 v37, v91, v90, s68
    v_add_f32 v32, v32, v88
    v_add_f32 v33, v33, v89
    v_sad_u8 v28, v36, v38, v28
    v_add_f32 v34, v34, v90
    v_add_f32 v35, v35, v91
    v_sad_u8 v28, v37, v39, v28
    s_waitcnt vmcnt(8)
    v_perm_b32 v36, v93, v92, s68
    v_perm_b32 v37, v95, v94, s68
    v_add_f32 v32, v32, v92
    v_add_f32 v33, v33, v93
    v_sad_u8 v28, v36, v38, v28
    v_add_f32 v34, v34, v94
    v_add_f32 v35, v35, v95
    v_sad_u8 v28, v37, v39, v28
    v_cmp_ne_u32 vcc, 0, v28
    s_cbranch_vccz L_got_10
    buffer_load_dwordx4 v[64:67], v9, s[52:55], s72 offen offset:0 sc1
    buffer_load_dwordx4 v[68:71], v9, s[52:55], s72 offen offset:1024 sc1
    buffer_load_dwordx4 v[72:75], v9, s[52:55], s72 offen offset:2048 sc1
    buffer_load_dwordx4 v[76:79], v9, s[52:55], s72 offen offset:3072 sc1
    buffer_load_dwordx4 v[80:83], v9, s[52:55], s75 offen offset:0 sc1
    buffer_load_dwordx4 v[84:87], v9, s[52:55], s75 offen offset:1024 sc1
    buffer_load_dwordx4 v[88:91], v9, s[52:55], s75 offen offset:2048 sc1
    buffer_load_dwordx4 v[92:95], v9, s[52:55], s75 offen offset:3072 sc1
    s_waitcnt vmcnt(15)
    v_perm_b32 v36, v129, v128, s68
    v_perm_b32 v37, v131, v130, s68
    v_sad_u8 v28, v36, v38, 0
    v_sad_u8 v28, v37, v39, v28
    s_waitcnt vmcnt(14)
    v_perm_b32 v36, v133, v132, s68
    v_perm_b32 v37, v135, v134, s68
    v_add_f32 v32, v128, v132
    v_add_f32 v33, v129, v133
    v_sad_u8 v28, v36, v38, v28
    v_add_f32 v34, v130, v134
    v_add_f32 v35, v131, v135
    v_sad_u8 v28, v37, v39, v28
    s_waitcnt vmcnt(13)
    v_perm_b32 v36, v137, v136, s68
    v_perm_b32 v37, v139, v138, s68
    v_add_f32 v32, v32, v136
    v_add_f32 v33, v33, v137
    v_sad_u8 v28, v36, v38, v28
    v_add_f32 v34, v34, v138
    v_add_f32 v35, v35, v139
    v_sad_u8 v28, v37, v39, v28
    s_waitcnt vmcnt(12)
    v_perm_b32 v36, v141, v140, s68
    v_perm_b32 v37, v143, v142, s68
    v_add_f32 v32, v32, v140
    v_add_f32 v33, v33, v141
    v_sad_u8 v28, v36, v38, v28
    v_add_f32 v34, v34, v142
    v_add_f32 v35, v35, v143
    v_sad_u8 v28, v37, v39, v28
    s_waitcnt vmcnt(11)
    v_perm_b32 v36, v145, v144, s68
    v_perm_b32 v37, v147, v146, s68
    v_add_f32 v32, v32, v144
    v_add_f32 v33, v33, v145
    v_sad_u8 v28, v36, v38, v28
    v_add_f32 v34, v34, v146
    v_add_f32 v35, v35, v147
    v_sad_u8 v28, v37, v39, v28
    s_waitcnt vmcnt(10)
    v_perm_b32 v36, v149, v148, s68
    v_perm_b32 v37, v151, v150, s68
    v_add_f32 v32, v32, v148
    v_add_f32 v33, v33, v149
    v_sad_u8 v28, v36, v38, v28
    v_add_f32 v34, v34, v150
    v_add_f32 v35, v35, v151
    v_sad_u8 v28, v37, v39, v28
    s_waitcnt vmcnt(9)
    v_perm_b32 v36, v153, v152, s68
    v_perm_b32 v37, v155, v154, s68
    v_add_f32 v32, v32, v152
    v_add_f32 v33, v33, v153
    v_sad_u8 v28, v36, v38, v28
    v_add_f32 v34, v34, v154
    v_add_f32 v35, v35, v155
    v_sad_u8 v28, v37, v39, v28
    s_waitcnt vmcnt(8)
    v_perm_b32 v36, v157, v156, s68
    v_perm_b32 v37, v159, v158, s68
    v_add_f32 v32, v32, v156
    v_add_f32 v33, v33, v157
    v_sad_u8 v28, v36, v38, v28
    v_add_f32 v34, v34, v158
    v_add_f32 v35, v35, v159
    v_sad_u8 v28, v37, v39, v28
    v_cmp_ne_u32 vcc, 0, v28
    s_sub_u32 s70, s70, 1
    s_cbranch_scc1 L_to_12
    s_cbranch_vccnz L_b_y_l
L_out_11:
L_got_10:
    v_permlane32_swap_b32 v32, v34
    v_permlane32_swap_b32 v33, v35
    v_add_f32 v32, v32, v34
    v_add_f32 v33, v33, v35
    s_nop 1
    v_permlane16_swap_b32 v32, v33
    v_add_f32 v32, v32, v33
    s_nop 1
    v_add_f32_dpp v32, v32, v32 row_ror:4 row_mask:0xf bank_mask:0xf
    s_nop 1
    v_add_f32_dpp v32, v32, v32 row_ror:8 row_mask:0xf bank_mask:0xf
    v_cvt_pk_bf16_f32 v32, v32, v32
    v_and_b32 v32, 0xffff0000, v32
    v_mul_f32 v32, v32, v17
    v_cvt_pk_bf16_f32 v32, v32, v32
    v_and_b32 v32, 0xffff0000, v32
    v_add_f32 v32, v32, v16
    v_cvt_pk_bf16_f32 v30, v32, v32
    v_bfi_b32 v32, v42, v30, v43
    v_bfi_b32 v33, v42, v30, v43
    s_nop 1
    v_permlane16_swap_b32 v32, v33
    v_mov_b32 v34, v32
    v_mov_b32 v35, v33
    s_nop 0
    v_permlane32_swap_b32 v32, v34
    v_permlane32_swap_b32 v33, v35
    buffer_store_dwordx4 v[32:35], v44, s[52:55], s73 offen sc1
    v_and_b32 v16, 0xffff0000, v30
    s_mov_b32 s70, s98
L_d_op:
    buffer_load_dwordx4 v[64:67], v9, s[52:55], s74 offen offset:0 sc1
    buffer_load_dwordx4 v[68:71], v9, s[52:55], s74 offen offset:1024 sc1
    buffer_load_dwordx4 v[72:75], v14, s[52:55], s74 offen offset:2048 sc1
    s_waitcnt vmcnt(2)
    v_perm_b32 v36, v65, v64, s68
    v_perm_b32 v37, v67, v66, s68
    v_sad_u8 v28, v36, v38, 0
    v_sad_u8 v28, v37, v39, v28
    s_waitcnt vmcnt(1)
    v_perm_b32 v36, v69, v68, s68
    v_perm_b32 v37, v71, v70, s68
    v_add_f32 v32, v64, v68
    v_add_f32 v33, v65, v69
    v_sad_u8 v28, v36, v38, v28
    v_add_f32 v34, v66, v70
    v_add_f32 v35, v67, v71
    v_sad_u8 v28, v37, v39, v28
    s_waitcnt vmcnt(0)
    v_perm_b32 v36, v73, v72, s68
    v_perm_b32 v37, v75, v74, s68
    v_add_f32 v32, v32, v72
    v_add_f32 v33, v33, v73
    v_sad_u8 v28, v36, v40, v28
    v_add_f32 v34, v34, v74
    v_add_f32 v35, v35, v75
    v_sad_u8 v28, v37, v41, v28
    v_cmp_ne_u32 vcc, 0, v28
    s_sub_u32 s70, s70, 1
    s_cbranch_scc1 L_to_14
    s_cbranch_vccnz L_d_op
L_out_13:
    v_permlane32_swap_b32 v32, v34
    v_permlane32_swap_b32 v33, v35
    v_add_f32 v32, v32, v34
    v_add_f32 v33, v33, v35
    s_nop 1
    v_permlane16_swap_b32 v32, v33
    v_add_f32 v32, v32, v33
    s_nop 1
    v_add_f32_dpp v32, v32, v32 row_ror:4 row_mask:0xf bank_mask:0xf
    s_nop 1
    v_add_f32_dpp v32, v32, v32 row_ror:8 row_mask:0xf bank_mask:0xf
    v_cvt_pk_bf16_f32 v32, v32, v32
    v_and_b32 v32, 0xffff0000, v32
    v_mul_f32 v32, v32, v18
    v_cvt_pk_bf16_f32 v32, v32, v32
    v_and_b32 v32, 0xffff0000, v32
    v_add_f32 v32, v32, v16
    v_cvt_pk_bf16_f32 v30, v32, v32
    v_mov_b32 v32, v30
    v_mov_b32 v33, v30
    s_nop 1
    v_permlane16_swap_b32 v32, v33
    v_perm_b32 v32, v32, v33, s12
    v_mov_b32 v33, v32
    s_nop 1
    v_permlane32_swap_b32 v32, v33
    buffer_store_dwordx2 v[32:33], v12, s[60:63], s15 offen
    s_cmp_lg_u32 s77, 0
    s_cbranch_scc1 L_fin3
    buffer_store_dword v11, v10, s[52:55], 0 offen sc1
L_fin3:
    s_branch L_fin
L_service:
    s_setprio 3
    s_lshr_b32 s12, s2, 4
    s_lshl_b32 s77, s4, 3
    s_and_b32 s13, s12, 7
    s_add_u32 s77, s77, s13
    s_mov_b32 s72, s77
    s_lshr_b32 s76, s12, 3
    s_lshl_b32 s76, s76, 2
    s_cmp_ge_u32 s9, 2
    s_cbranch_scc1 L_role_15
    s_lshl_b32 s72, s4, 4
    s_add_u32 s72, s72, s12
    s_add_u32 s72, s72, 64
    s_lshr_b32 s77, s4, 1
    s_mul_i32 s77, s77, 11
    s_add_u32 s77, s77, s12
    s_cmp_lt_u32 s77, 43
    s_cselect_b32 s76, 1, 0
    s_cmp_lt_u32 s12, 11
    s_cselect_b32 s76, s76, 0
    s_cmp_eq_u32 s9, 0
    s_cselect_b32 s76, s76, 0
L_role_15:
    s_sub_u32 s12, s3, 4
    s_lshl_b32 s13, s12, 13
    v_lshlrev_b32 v13, 4, v1
    v_add_u32 v7, s13, v13
    v_lshlrev_b32 v8, 11, v3
    v_lshl_add_u32 v8, v4, 8, v8
    v_lshl_add_u32 v8, v5, 3, v8
    v_add_u32 v8, s13, v8
    v_mov_b32 v31, 0x7ff00000
    s_mov_b32 s68, 0x3727c5ac
    s_mov_b32 s69, 0x3fb8aa3b
    s_waitcnt lgkmcnt(0)
    s_load_dword s11, s[42:43], 0
    s_mov_b32 s52, s42
    s_mov_b32 s53, s43
    s_mov_b32 s54, 0x188000
    s_mov_b32 s55, 0x20000
    s_cmp_eq_u32 s3, 4
    s_cbranch_scc1 L_s_q
    s_cmp_eq_u32 s3, 5
    s_cbranch_scc1 L_s_warm
    s_cmp_eq_u32 s3, 6
    s_cbranch_scc1 L_s_bar1
    s_cmp_eq_u32 s76, 4
    s_cbranch_scc1 L_s_bar1
    s_mov_b32 s48, s36
    s_mov_b32 s49, s37
    s_mov_b32 s50, 0x300000
    s_mov_b32 s51, 0x20000
    s_mov_b32 s60, s34
    s_mov_b32 s61, s35
    s_mov_b32 s62, 0x800
    s_mov_b32 s63, 0x20000
    s_lshr_b32 s13, s72, 2
    s_and_b32 s14, s72, 3
    s_lshl_b32 s65, s13, 7
    s_mul_i32 s64, s14, 786432
    s_add_u32 s65, s65, s64
    s_lshl_b32 s64, s14, 8
    v_lshrrev_b32 v9, 3, v1
    v_mul_u32_u24 v9, 6144, v9
    v_and_b32 v11, 7, v1
    v_lshl_add_u32 v9, v11, 4, v9
    v_lshrrev_b32 v11, 5, v1
    v_and_b32 v12, 31, v1
    v_lshlrev_b32 v12, 3, v12
    v_lshl_add_u32 v14, v11, 10, v12
    buffer_load_dwordx2 v[16:17], v14, s[60:63], s64 offen
    buffer_load_dwordx4 v[192:195], v9, s[48:51], s65 offen nt
    s_add_u32 s65, s65, 0xc000
    buffer_load_dwordx4 v[196:199], v9, s[48:51], s65 offen nt
    s_add_u32 s65, s65, 0xc000
    buffer_load_dwordx4 v[200:203], v9, s[48:51], s65 offen nt
    s_add_u32 s65, s65, 0xc000
    buffer_load_dwordx4 v[204:207], v9, s[48:51], s65 offen nt
    s_add_u32 s65, s65, 0xc000
    buffer_load_dwordx4 v[208:211], v9, s[48:51], s65 offen nt
    s_add_u32 s65, s65, 0xc000
    buffer_load_dwordx4 v[212:215], v9, s[48:51], s65 offen nt
    s_add_u32 s65, s65, 0xc000
    buffer_load_dwordx4 v[216:219], v9, s[48:51], s65 offen nt
    s_add_u32 s65, s65, 0xc000
    buffer_load_dwordx4 v[220:223], v9, s[48:51], s65 offen nt
    s_add_u32 s65, s65, 0xc000
    v_lshl_add_u32 v15, v11, 8, v12
    v_add_u32 v15, 147712, v15
    v_lshlrev_b32 v11, 10, v3
    v_lshl_add_u32 v11, v4, 7, v11
    v_lshl_add_u32 v11, v5, 3, v11
    v_add_u32 v11, 24576, v11
    v_and_b32 v28, 1, v4
    v_lshlrev_b32 v12, 8, v28
    v_lshl_add_u32 v12, v3, 4, v12
    v_add_u32 v12, 147712, v12
    s_waitcnt vmcnt(8)
    v_lshlrev_b32 v20, 16, v16
    v_and_b32 v21, 0xffff0000, v16
    v_lshlrev_b32 v22, 16, v17
    v_and_b32 v23, 0xffff0000, v17
    v_mul_f32 v24, s69, v20
    v_mul_f32 v25, s69, v21
    v_mul_f32 v26, s69, v22
    v_mul_f32 v27, s69, v23
    v_exp_f32 v24, -v24
    v_exp_f32 v25, -v25
    v_exp_f32 v26, -v26
    v_exp_f32 v27, -v27
    v_add_f32 v24, 1.0, v24
    v_add_f32 v25, 1.0, v25
    v_add_f32 v26, 1.0, v26
    v_add_f32 v27, 1.0, v27
    v_rcp_f32 v24, v24
    v_rcp_f32 v25, v25
    v_rcp_f32 v26, v26
    v_rcp_f32 v27, v27
    v_mul_f32 v20, v20, v24
    v_mul_f32 v21, v21, v25
    v_mul_f32 v22, v22, v26
    v_mul_f32 v23, v23, v27
    v_cvt_pk_bf16_f32 v16, v20, v21
    v_cvt_pk_bf16_f32 v17, v22, v23
    ds_write_b64 v15, v[16:17]
    ds_read_b128 v[32:35], v12 offset:0
    ds_read_b128 v[36:39], v12 offset:64
    ds_read_b128 v[40:43], v12 offset:128
    ds_read_b128 v[44:47], v12 offset:192
    s_waitcnt vmcnt(7)
    buffer_load_dwordx4 v[224:227], v9, s[48:51], s65 offen nt
    s_add_u32 s65, s65, 0xc000
    s_waitcnt vmcnt(7)
    buffer_load_dwordx4 v[228:231], v9, s[48:51], s65 offen nt
    s_add_u32 s65, s65, 0xc000
    s_waitcnt vmcnt(7)
    buffer_load_dwordx4 v[232:235], v9, s[48:51], s65 offen nt
    s_add_u32 s65, s65, 0xc000
    s_waitcnt vmcnt(7)
    buffer_load_dwordx4 v[236:239], v9, s[48:51], s65 offen nt
    s_add_u32 s65, s65, 0xc000
    s_waitcnt vmcnt(7)
    buffer_load_dwordx4 v[240:243], v9, s[48:51], s65 offen nt
    s_add_u32 s65, s65, 0xc000
    s_waitcnt vmcnt(7)
    buffer_load_dwordx4 v[244:247], v9, s[48:51], s65 offen nt
    s_add_u32 s65, s65, 0xc000
    s_waitcnt vmcnt(7)
    buffer_load_dwordx4 v[248:251], v9, s[48:51], s65 offen nt
    s_add_u32 s65, s65, 0xc000
    s_waitcnt vmcnt(7)
    buffer_load_dwordx4 v[252:255], v9, s[48:51], s65 offen nt
    s_waitcnt vmcnt(15)
    ds_write_b128 v7, v[192:195] offset:0
    s_waitcnt vmcnt(14)
    ds_write_b128 v7, v[196:199] offset:1024
    s_waitcnt vmcnt(13)
    ds_write_b128 v7, v[200:203] offset:2048
    s_waitcnt vmcnt(12)
    ds_write_b128 v7, v[204:207] offset:3072
    ds_read_b64_tr_b16 v[192:193], v11 offset:0
    ds_read_b64_tr_b16 v[194:195], v11 offset:512
    ds_read_b64_tr_b16 v[196:197], v11 offset:32
    ds_read_b64_tr_b16 v[198:199], v11 offset:544
    ds_read_b64_tr_b16 v[200:201], v11 offset:64
    ds_read_b64_tr_b16 v[202:203], v11 offset:576
    ds_read_b64_tr_b16 v[204:205], v11 offset:96
    ds_read_b64_tr_b16 v[206:207], v11 offset:608
    s_waitcnt vmcnt(11)
    ds_write_b128 v7, v[208:211] offset:4096
    s_waitcnt vmcnt(10)
    ds_write_b128 v7, v[212:215] offset:5120
    s_waitcnt vmcnt(9)
    ds_write_b128 v7, v[216:219] offset:6144
    s_waitcnt vmcnt(8)
    ds_write_b128 v7, v[220:223] offset:7168
    ds_read_b64_tr_b16 v[208:209], v11 offset:4096
    ds_read_b64_tr_b16 v[210:211], v11 offset:4608
    ds_read_b64_tr_b16 v[212:213], v11 offset:4128
    ds_read_b64_tr_b16 v[214:215], v11 offset:4640
    ds_read_b64_tr_b16 v[216:217], v11 offset:4160
    ds_read_b64_tr_b16 v[218:219], v11 offset:4672
    ds_read_b64_tr_b16 v[220:221], v11 offset:4192
    ds_read_b64_tr_b16 v[222:223], v11 offset:4704
    s_waitcnt vmcnt(7)
    ds_write_b128 v7, v[224:227] offset:0
    s_waitcnt vmcnt(6)
    ds_write_b128 v7, v[228:231] offset:1024
    s_waitcnt vmcnt(5)
    ds_write_b128 v7, v[232:235] offset:2048
    s_waitcnt vmcnt(4)
    ds_write_b128 v7, v[236:239] offset:3072
    ds_read_b64_tr_b16 v[224:225], v11 offset:0
    ds_read_b64_tr_b16 v[226:227], v11 offset:512
    ds_read_b64_tr_b16 v[228:229], v11 offset:32
    ds_read_b64_tr_b16 v[230:231], v11 offset:544
    ds_read_b64_tr_b16 v[232:233], v11 offset:64
    ds_read_b64_tr_b16 v[234:235], v11 offset:576
    ds_read_b64_tr_b16 v[236:237], v11 offset:96
    ds_read_b64_tr_b16 v[238:239], v11 offset:608
    s_waitcnt vmcnt(3)
    ds_write_b128 v7, v[240:243] offset:4096
    s_waitcnt vmcnt(2)
    ds_write_b128 v7, v[244:247] offset:5120
    s_waitcnt vmcnt(1)
    ds_write_b128 v7, v[248:251] offset:6144
    s_waitcnt vmcnt(0)
    ds_write_b128 v7, v[252:255] offset:7168
    ds_read_b64_tr_b16 v[240:241], v11 offset:4096
    ds_read_b64_tr_b16 v[242:243], v11 offset:4608
    ds_read_b64_tr_b16 v[244:245], v11 offset:4128
    ds_read_b64_tr_b16 v[246:247], v11 offset:4640
    ds_read_b64_tr_b16 v[248:249], v11 offset:4160
    ds_read_b64_tr_b16 v[250:251], v11 offset:4672
    ds_read_b64_tr_b16 v[252:253], v11 offset:4192
    ds_read_b64_tr_b16 v[254:255], v11 offset:4704
    s_waitcnt lgkmcnt(12)
    v_mfma_f32_16x16x32_bf16 v[48:51], v[192:195], v[32:35], 0
    v_mfma_f32_16x16x32_bf16 v[52:55], v[196:199], v[32:35], 0
    v_mfma_f32_16x16x32_bf16 v[56:59], v[200:203], v[32:35], 0
    v_mfma_f32_16x16x32_bf16 v[60:63], v[204:207], v[32:35], 0
    s_waitcnt lgkmcnt(12)
    v_mfma_f32_16x16x32_bf16 v[48:51], v[208:211], v[36:39], v[48:51]
    v_mfma_f32_16x16x32_bf16 v[52:55], v[212:215], v[36:39], v[52:55]
    v_mfma_f32_16x16x32_bf16 v[56:59], v[216:219], v[36:39], v[56:59]
    v_mfma_f32_16x16x32_bf16 v[60:63], v[220:223], v[36:39], v[60:63]
    s_waitcnt lgkmcnt(12)
    v_mfma_f32_16x16x32_bf16 v[48:51], v[224:227], v[40:43], v[48:51]
    v_mfma_f32_16x16x32_bf16 v[52:55], v[228:231], v[40:43], v[52:55]
    v_mfma_f32_16x16x32_bf16 v[56:59], v[232:235], v[40:43], v[56:59]
    v_mfma_f32_16x16x32_bf16 v[60:63], v[236:239], v[40:43], v[60:63]
    s_waitcnt lgkmcnt(0)
    v_mfma_f32_16x16x32_bf16 v[48:51], v[240:243], v[44:47], v[48:51]
    v_mfma_f32_16x16x32_bf16 v[52:55], v[244:247], v[44:47], v[52:55]
    v_mfma_f32_16x16x32_bf16 v[56:59], v[248:251], v[44:47], v[56:59]
    v_mfma_f32_16x16x32_bf16 v[60:63], v[252:255], v[44:47], v[60:63]
    s_add_u32 s10, s11, 0x9e3779b9
    v_cmp_eq_u32 vcc, 1, v5
    s_nop 3
    v_cndmask_b32 v48, v48, v52, vcc
    v_cndmask_b32 v49, v49, v53, vcc
    v_cndmask_b32 v50, v50, v54, vcc
    v_cndmask_b32 v51, v51, v55, vcc
    v_cmp_eq_u32 vcc, 2, v5
    s_nop 1
    v_cndmask_b32 v48, v48, v56, vcc
    v_cndmask_b32 v49, v49, v57, vcc
    v_cndmask_b32 v50, v50, v58, vcc
    v_cndmask_b32 v51, v51, v59, vcc
    v_cmp_eq_u32 vcc, 3, v5
    s_nop 1
    v_cndmask_b32 v48, v48, v60, vcc
    v_cndmask_b32 v49, v49, v61, vcc
    v_cndmask_b32 v50, v50, v62, vcc
    v_cndmask_b32 v51, v51, v63, vcc
    v_cmp_gt_u32 vcc, 8, v2
    v_mov_b32 v52, s10
    s_nop 0
    v_cndmask_b32 v48, v51, v48, vcc
    v_cndmask_b32 v49, v52, v49, vcc
    v_cndmask_b32 v50, v52, v50, vcc
    v_mov_b32 v51, s10
    s_lshl_b32 s13, s72, 10
    s_add_u32 s13, s13, 1376256
    buffer_store_dwordx4 v[48:51], v13, s[52:55], s13 offen sc1
    s_branch L_s_bar1
L_s_warm:
    s_getpc_b64 s[66:67]
L_pc:
    s_sub_u32 s66, s66, L_pc-adaLN_cond__mha_block_cached__glu_gated_swiglu__decode_kernel
    s_subb_u32 s67, s67, 0
    s_and_b32 s13, s5, 31
    s_mul_i32 s13, s13, 1024
    v_add_u32 v14, s13, v13
    v_min_u32 v15, L_codeend-adaLN_cond__mha_block_cached__glu_gated_swiglu__decode_kernel-16, v14
    global_load_dwordx4 v[20:23], v15, s[66:67]
    v_add_u32 v14, 1024, v14
    s_branch L_s_bar1
L_s_q:
    s_mov_b32 s44, s22
    s_mov_b32 s45, s23
    s_mov_b32 s46, 0x400000
    s_mov_b32 s47, 0x20000
    s_mov_b32 s56, s16
    s_mov_b32 s57, s17
    s_mov_b32 s58, 0x800
    s_mov_b32 s59, 0x20000
    v_lshlrev_b32 v6, 13, v3
    v_lshl_add_u32 v6, v2, 4, v6
    s_lshl_b32 s64, s6, 8
    s_lshl_b32 s13, s7, 19
    s_add_u32 s64, s64, s13
    buffer_load_dwordx4 v[24:27], v13, s[56:59], 0 offen
    buffer_load_dwordx4 v[28:31], v13, s[56:59], 0 offen offset:1024
    buffer_load_dwordx4 v[64:67], v6, s[44:47], s64 offen nt
    s_add_u32 s64, s64, 0x8000
    buffer_load_dwordx4 v[68:71], v6, s[44:47], s64 offen nt
    s_add_u32 s64, s64, 0x8000
    buffer_load_dwordx4 v[72:75], v6, s[44:47], s64 offen nt
    s_add_u32 s64, s64, 0x8000
    buffer_load_dwordx4 v[76:79], v6, s[44:47], s64 offen nt
    s_add_u32 s64, s64, 0x8000
    buffer_load_dwordx4 v[80:83], v6, s[44:47], s64 offen nt
    s_add_u32 s64, s64, 0x8000
    buffer_load_dwordx4 v[84:87], v6, s[44:47], s64 offen nt
    s_add_u32 s64, s64, 0x8000
    buffer_load_dwordx4 v[88:91], v6, s[44:47], s64 offen nt
    s_add_u32 s64, s64, 0x8000
    buffer_load_dwordx4 v[92:95], v6, s[44:47], s64 offen nt
    s_add_u32 s64, s64, 0x8000
    buffer_load_dwordx4 v[96:99], v6, s[44:47], s64 offen nt
    s_add_u32 s64, s64, 0x8000
    buffer_load_dwordx4 v[100:103], v6, s[44:47], s64 offen nt
    s_add_u32 s64, s64, 0x8000
    buffer_load_dwordx4 v[104:107], v6, s[44:47], s64 offen nt
    s_add_u32 s64, s64, 0x8000
    buffer_load_dwordx4 v[108:111], v6, s[44:47], s64 offen nt
    s_add_u32 s64, s64, 0x8000
    buffer_load_dwordx4 v[112:115], v6, s[44:47], s64 offen nt
    s_add_u32 s64, s64, 0x8000
    buffer_load_dwordx4 v[116:119], v6, s[44:47], s64 offen nt
    s_add_u32 s64, s64, 0x8000
    buffer_load_dwordx4 v[120:123], v6, s[44:47], s64 offen nt
    s_add_u32 s64, s64, 0x8000
    buffer_load_dwordx4 v[124:127], v6, s[44:47], s64 offen nt
    v_and_b32 v63, 7, v1
    v_lshrrev_b32 v16, 5, v1
    v_and_b32 v19, 1, v3
    v_lshlrev_b32 v14, 15, v16
    v_lshl_add_u32 v14, v5, 8, v14
    v_lshl_add_u32 v14, v19, 6, v14
    v_lshl_add_u32 v14, v4, 4, v14
    v_bfe_u32 v17, v1, 3, 2
    v_lshlrev_b32 v6, 10, v16
    v_lshl_add_u32 v6, v17, 8, v6
    v_lshl_add_u32 v6, v63, 4, v6
    v_lshlrev_b32 v23, 5, v63
    v_lshl_add_u32 v23, v17, 3, v23
    v_lshl_add_u32 v23, v16, 2, v23
    v_add_u32 v23, 148224, v23
    v_lshlrev_b32 v18, 3, v2
    v_lshl_add_u32 v18, v16, 2, v18
    v_lshl_add_u32 v11, v19, 7, v18
    v_add_u32 v11, 147456, v11
    v_lshl_add_u32 v15, v19, 10, v18
    s_lshl_b32 s13, s7, 7
    s_add_u32 s13, s13, 150752
    v_add_u32 v15, s13, v15
    v_bfe_u32 v12, v1, 3, 1
    v_lshlrev_b32 v12, 7, v12
    v_lshl_add_u32 v12, v3, 4, v12
    v_add_u32 v12, 147456, v12
    s_waitcnt vmcnt(16)
    v_lshlrev_b32 v32, 16, v24
    v_and_b32 v33, 0xffff0000, v24
    v_lshlrev_b32 v34, 16, v25
    v_and_b32 v35, 0xffff0000, v25
    v_lshlrev_b32 v36, 16, v26
    v_and_b32 v37, 0xffff0000, v26
    v_lshlrev_b32 v38, 16, v27
    v_and_b32 v39, 0xffff0000, v27
    v_add_f32 v40, v32, v33
    v_add_f32 v41, v34, v35
    v_add_f32 v42, v36, v37
    v_add_f32 v43, v38, v39
    v_add_f32 v40, v40, v41
    v_add_f32 v42, v42, v43
    v_add_f32 v40, v40, v42
    s_nop 1
    v_add_f32_dpp v40, v40, v40 row_ror:8 row_mask:0xf bank_mask:0xf
    s_nop 1
    v_add_f32_dpp v40, v40, v40 row_ror:4 row_mask:0xf bank_mask:0xf
    s_nop 1
    v_add_f32_dpp v40, v40, v40 row_ror:2 row_mask:0xf bank_mask:0xf
    s_nop 1
    v_add_f32_dpp v40, v40, v40 row_ror:1 row_mask:0xf bank_mask:0xf
    s_nop 1
    v_add_f32_dpp v40, v40, v40 row_bcast:15 row_mask:0xa bank_mask:0xf
    s_nop 1
    v_add_f32_dpp v40, v40, v40 row_bcast:31 row_mask:0xc bank_mask:0xf
    s_nop 0
    v_readlane_b32 s71, v40, 63
    v_mov_b32 v41, 0x3b000000
    s_nop 0
    v_mul_f32 v40, s71, v41
    v_cvt_pk_bf16_f32 v42, v40, v40
    v_sub_f32 v44, v32, v40
    v_sub_f32 v45, v33, v40
    v_sub_f32 v46, v34, v40
    v_sub_f32 v47, v35, v40
    v_sub_f32 v48, v36, v40
    v_sub_f32 v49, v37, v40
    v_sub_f32 v50, v38, v40
    v_sub_f32 v51, v39, v40
    v_and_b32 v42, 0xffff0000, v42
    v_mul_f32 v43, v44, v44
    v_mul_f32 v40, v45, v45
    v_fmac_f32 v43, v46, v46
    v_fmac_f32 v40, v47, v47
    v_fmac_f32 v43, v48, v48
    v_fmac_f32 v40, v49, v49
    v_fmac_f32 v43, v50, v50
    v_fmac_f32 v40, v51, v51
    v_add_f32 v43, v43, v40
    v_sub_f32 v32, v32, v42
    v_sub_f32 v33, v33, v42
    v_add_f32_dpp v43, v43, v43 row_ror:8 row_mask:0xf bank_mask:0xf
    v_sub_f32 v34, v34, v42
    v_sub_f32 v35, v35, v42
    v_add_f32_dpp v43, v43, v43 row_ror:4 row_mask:0xf bank_mask:0xf
    v_sub_f32 v36, v36, v42
    v_sub_f32 v37, v37, v42
    v_add_f32_dpp v43, v43, v43 row_ror:2 row_mask:0xf bank_mask:0xf
    v_sub_f32 v38, v38, v42
    v_sub_f32 v39, v39, v42
    v_add_f32_dpp v43, v43, v43 row_ror:1 row_mask:0xf bank_mask:0xf
    v_cvt_pk_bf16_f32 v44, v32, v33
    v_cvt_pk_bf16_f32 v45, v34, v35
    v_add_f32_dpp v43, v43, v43 row_bcast:15 row_mask:0xa bank_mask:0xf
    v_cvt_pk_bf16_f32 v46, v36, v37
    v_cvt_pk_bf16_f32 v47, v38, v39
    v_add_f32_dpp v43, v43, v43 row_bcast:31 row_mask:0xc bank_mask:0xf
    v_lshlrev_b32 v32, 16, v44
    v_and_b32 v33, 0xffff0000, v44
    v_readlane_b32 s71, v43, 63
    v_lshlrev_b32 v34, 16, v45
    v_and_b32 v35, 0xffff0000, v45
    v_mul_f32 v40, s71, v41
    v_lshlrev_b32 v36, 16, v46
    v_and_b32 v37, 0xffff0000, v46
    v_cvt_pk_bf16_f32 v40, v40, v40
    v_lshlrev_b32 v38, 16, v47
    v_and_b32 v39, 0xffff0000, v47
    v_and_b32 v40, 0xffff0000, v40
    v_add_f32 v40, s68, v40
    v_cvt_pk_bf16_f32 v40, v40, v40
    v_and_b32 v40, 0xffff0000, v40
    v_sqrt_f32 v40, v40
    s_nop 0
    v_cvt_pk_bf16_f32 v40, v40, v40
    v_and_b32 v40, 0xffff0000, v40
    v_rcp_f32 v40, v40
    s_nop 0
    v_mul_f32 v32, v32, v40
    v_mul_f32 v33, v33, v40
    v_mul_f32 v34, v34, v40
    v_mul_f32 v35, v35, v40
    v_mul_f32 v36, v36, v40
    v_mul_f32 v37, v37, v40
    v_mul_f32 v38, v38, v40
    v_mul_f32 v39, v39, v40
    v_cvt_pk_bf16_f32 v44, v32, v33
    v_cvt_pk_bf16_f32 v45, v34, v35
    v_cvt_pk_bf16_f32 v46, v36, v37
    v_cvt_pk_bf16_f32 v47, v38, v39
    v_lshlrev_b32 v32, 16, v44
    v_and_b32 v33, 0xffff0000, v44
    v_lshlrev_b32 v34, 16, v45
    v_and_b32 v35, 0xffff0000, v45
    v_lshlrev_b32 v36, 16, v46
    v_and_b32 v37, 0xffff0000, v46
    v_lshlrev_b32 v38, 16, v47
    v_and_b32 v39, 0xffff0000, v47
    v_add_u32 v16, 150752, v13
    ds_write_b128 v16, v[44:47]
    v_lshlrev_b32 v32, 16, v28
    v_and_b32 v33, 0xffff0000, v28
    v_lshlrev_b32 v34, 16, v29
    v_and_b32 v35, 0xffff0000, v29
    v_lshlrev_b32 v36, 16, v30
    v_and_b32 v37, 0xffff0000, v30
    v_lshlrev_b32 v38, 16, v31
    v_and_b32 v39, 0xffff0000, v31
    v_add_f32 v40, v32, v33
    v_add_f32 v41, v34, v35
    v_add_f32 v42, v36, v37
    v_add_f32 v43, v38, v39
    v_add_f32 v40, v40, v41
    v_add_f32 v42, v42, v43
    v_add_f32 v40, v40, v42
    s_nop 1
    v_add_f32_dpp v40, v40, v40 row_ror:8 row_mask:0xf bank_mask:0xf
    s_nop 1
    v_add_f32_dpp v40, v40, v40 row_ror:4 row_mask:0xf bank_mask:0xf
    s_nop 1
    v_add_f32_dpp v40, v40, v40 row_ror:2 row_mask:0xf bank_mask:0xf
    s_nop 1
    v_add_f32_dpp v40, v40, v40 row_ror:1 row_mask:0xf bank_mask:0xf
    s_nop 1
    v_add_f32_dpp v40, v40, v40 row_bcast:15 row_mask:0xa bank_mask:0xf
    s_nop 1
    v_add_f32_dpp v40, v40, v40 row_bcast:31 row_mask:0xc bank_mask:0xf
    s_nop 0
    v_readlane_b32 s71, v40, 63
    v_mov_b32 v41, 0x3b000000
    s_nop 0
    v_mul_f32 v40, s71, v41
    v_cvt_pk_bf16_f32 v42, v40, v40
    v_sub_f32 v44, v32, v40
    v_sub_f32 v45, v33, v40
    v_sub_f32 v46, v34, v40
    v_sub_f32 v47, v35, v40
    v_sub_f32 v48, v36, v40
    v_sub_f32 v49, v37, v40
    v_sub_f32 v50, v38, v40
    v_sub_f32 v51, v39, v40
    v_and_b32 v42, 0xffff0000, v42
    v_mul_f32 v43, v44, v44
    v_mul_f32 v40, v45, v45
    v_fmac_f32 v43, v46, v46
    v_fmac_f32 v40, v47, v47
    v_fmac_f32 v43, v48, v48
    v_fmac_f32 v40, v49, v49
    v_fmac_f32 v43, v50, v50
    v_fmac_f32 v40, v51, v51
    v_add_f32 v43, v43, v40
    v_sub_f32 v32, v32, v42
    v_sub_f32 v33, v33, v42
    v_add_f32_dpp v43, v43, v43 row_ror:8 row_mask:0xf bank_mask:0xf
    v_sub_f32 v34, v34, v42
    v_sub_f32 v35, v35, v42
    v_add_f32_dpp v43, v43, v43 row_ror:4 row_mask:0xf bank_mask:0xf
    v_sub_f32 v36, v36, v42
    v_sub_f32 v37, v37, v42
    v_add_f32_dpp v43, v43, v43 row_ror:2 row_mask:0xf bank_mask:0xf
    v_sub_f32 v38, v38, v42
    v_sub_f32 v39, v39, v42
    v_add_f32_dpp v43, v43, v43 row_ror:1 row_mask:0xf bank_mask:0xf
    v_cvt_pk_bf16_f32 v44, v32, v33
    v_cvt_pk_bf16_f32 v45, v34, v35
    v_add_f32_dpp v43, v43, v43 row_bcast:15 row_mask:0xa bank_mask:0xf
    v_cvt_pk_bf16_f32 v46, v36, v37
    v_cvt_pk_bf16_f32 v47, v38, v39
    v_add_f32_dpp v43, v43, v43 row_bcast:31 row_mask:0xc bank_mask:0xf
    v_lshlrev_b32 v32, 16, v44
    v_and_b32 v33, 0xffff0000, v44
    v_readlane_b32 s71, v43, 63
    v_lshlrev_b32 v34, 16, v45
    v_and_b32 v35, 0xffff0000, v45
    v_mul_f32 v40, s71, v41
    v_lshlrev_b32 v36, 16, v46
    v_and_b32 v37, 0xffff0000, v46
    v_cvt_pk_bf16_f32 v40, v40, v40
    v_lshlrev_b32 v38, 16, v47
    v_and_b32 v39, 0xffff0000, v47
    v_and_b32 v40, 0xffff0000, v40
    v_add_f32 v40, s68, v40
    v_cvt_pk_bf16_f32 v40, v40, v40
    v_and_b32 v40, 0xffff0000, v40
    v_sqrt_f32 v40, v40
    s_nop 0
    v_cvt_pk_bf16_f32 v40, v40, v40
    v_and_b32 v40, 0xffff0000, v40
    v_rcp_f32 v40, v40
    s_nop 0
    v_mul_f32 v32, v32, v40
    v_mul_f32 v33, v33, v40
    v_mul_f32 v34, v34, v40
    v_mul_f32 v35, v35, v40
    v_mul_f32 v36, v36, v40
    v_mul_f32 v37, v37, v40
    v_mul_f32 v38, v38, v40
    v_mul_f32 v39, v39, v40
    v_cvt_pk_bf16_f32 v44, v32, v33
    v_cvt_pk_bf16_f32 v45, v34, v35
    v_cvt_pk_bf16_f32 v46, v36, v37
    v_cvt_pk_bf16_f32 v47, v38, v39
    v_lshlrev_b32 v32, 16, v44
    v_and_b32 v33, 0xffff0000, v44
    v_lshlrev_b32 v34, 16, v45
    v_and_b32 v35, 0xffff0000, v45
    v_lshlrev_b32 v36, 16, v46
    v_and_b32 v37, 0xffff0000, v46
    v_lshlrev_b32 v38, 16, v47
    v_and_b32 v39, 0xffff0000, v47
    v_add_u32 v16, 151776, v13
    ds_write_b128 v16, v[44:47]
    ds_read_b32 v22, v15
    v_mov_b32 v31, 0x7ff00000
    s_waitcnt vmcnt(15)
    ds_write_b128 v7, v[64:67] offset:0
    s_waitcnt vmcnt(14)
    ds_write_b128 v7, v[68:71] offset:1024
    s_waitcnt vmcnt(13)
    ds_write_b128 v7, v[72:75] offset:2048
    s_waitcnt vmcnt(12)
    ds_write_b128 v7, v[76:79] offset:3072
    s_waitcnt vmcnt(11)
    ds_write_b128 v7, v[80:83] offset:4096
    s_waitcnt vmcnt(10)
    ds_write_b128 v7, v[84:87] offset:5120
    s_waitcnt vmcnt(9)
    ds_write_b128 v7, v[88:91] offset:6144
    s_waitcnt vmcnt(8)
    ds_write_b128 v7, v[92:95] offset:7168
    ds_read_b64_tr_b16 v[64:65], v8 offset:0
    ds_read_b64_tr_b16 v[66:67], v8 offset:1024
    ds_read_b64_tr_b16 v[68:69], v8 offset:32
    ds_read_b64_tr_b16 v[70:71], v8 offset:1056
    ds_read_b64_tr_b16 v[72:73], v8 offset:64
    ds_read_b64_tr_b16 v[74:75], v8 offset:1088
    ds_read_b64_tr_b16 v[76:77], v8 offset:96
    ds_read_b64_tr_b16 v[78:79], v8 offset:1120
    ds_read_b64_tr_b16 v[80:81], v8 offset:128
    ds_read_b64_tr_b16 v[82:83], v8 offset:1152
    ds_read_b64_tr_b16 v[84:85], v8 offset:160
    ds_read_b64_tr_b16 v[86:87], v8 offset:1184
    ds_read_b64_tr_b16 v[88:89], v8 offset:192
    ds_read_b64_tr_b16 v[90:91], v8 offset:1216
    ds_read_b64_tr_b16 v[92:93], v8 offset:224
    ds_read_b64_tr_b16 v[94:95], v8 offset:1248
    s_waitcnt vmcnt(7)
    ds_write_b128 v7, v[96:99] offset:0
    s_waitcnt vmcnt(6)
    ds_write_b128 v7, v[100:103] offset:1024
    s_waitcnt vmcnt(5)
    ds_write_b128 v7, v[104:107] offset:2048
    s_waitcnt vmcnt(4)
    ds_write_b128 v7, v[108:111] offset:3072
    s_waitcnt vmcnt(3)
    ds_write_b128 v7, v[112:115] offset:4096
    s_waitcnt vmcnt(2)
    ds_write_b128 v7, v[116:119] offset:5120
    s_waitcnt vmcnt(1)
    ds_write_b128 v7, v[120:123] offset:6144
    s_waitcnt vmcnt(0)
    ds_write_b128 v7, v[124:127] offset:7168
    ds_read_b64_tr_b16 v[96:97], v8 offset:0
    ds_read_b64_tr_b16 v[98:99], v8 offset:1024
    ds_read_b64_tr_b16 v[100:101], v8 offset:32
    ds_read_b64_tr_b16 v[102:103], v8 offset:1056
    ds_read_b64_tr_b16 v[104:105], v8 offset:64
    ds_read_b64_tr_b16 v[106:107], v8 offset:1088
    ds_read_b64_tr_b16 v[108:109], v8 offset:96
    ds_read_b64_tr_b16 v[110:111], v8 offset:1120
    ds_read_b64_tr_b16 v[112:113], v8 offset:128
    ds_read_b64_tr_b16 v[114:115], v8 offset:1152
    ds_read_b64_tr_b16 v[116:117], v8 offset:160
    ds_read_b64_tr_b16 v[118:119], v8 offset:1184
    ds_read_b64_tr_b16 v[120:121], v8 offset:192
    ds_read_b64_tr_b16 v[122:123], v8 offset:1216
    ds_read_b64_tr_b16 v[124:125], v8 offset:224
    ds_read_b64_tr_b16 v[126:127], v8 offset:1248
    s_waitcnt lgkmcnt(0)
    s_add_u32 s10, s11, 0x9e3779b9
    s_lshl_b32 s13, s7, 12
    s_add_u32 s13, s13, 1376256
    v_mov_b32 v24, s10
    v_lshrrev_b32 v60, 1, v13
    v_lshrrev_b32 v61, 1, v6
    s_lshl_b32 s95, s6, 13
    s_lshl_b32 s64, s7, 10
    s_add_u32 s64, s64, s95
    s_lshr_b32 s92, s64, 1
    s_add_u32 s92, s92, 327680
    s_add_u32 s64, s64, 65536
    s_lshl_b32 s65, s8, 7
    s_add_u32 s95, s95, s65
    s_lshr_b32 s93, s95, 1
    s_add_u32 s93, s93, 327680
    s_add_u32 s95, s95, 65536
    s_add_u32 s65, s95, 4096
    s_mov_b32 s70, 262144
    v_lshlrev_b32 v26, 16, v22
    v_and_b32 v27, 0xffff0000, v22
    s_add_u32 s96, s42, s13
    s_addc_u32 s97, s43, 0
    s_mov_b32 s71, 64
L_sp1:
    s_load_dword s16, s[96:97], 780 glc
    s_load_dword s17, s[96:97], 1804 glc
    s_load_dword s18, s[96:97], 2828 glc
    s_load_dword s19, s[96:97], 3852 glc
    s_load_dword s20, s[96:97], 33548 glc
    s_load_dword s21, s[96:97], 34572 glc
    s_load_dword s22, s[96:97], 35596 glc
    s_load_dword s23, s[96:97], 36620 glc
    s_waitcnt lgkmcnt(0)
    s_xor_b32 s16, s16, s10
    s_xor_b32 s17, s17, s10
    s_xor_b32 s18, s18, s10
    s_xor_b32 s19, s19, s10
    s_xor_b32 s20, s20, s10
    s_xor_b32 s21, s21, s10
    s_xor_b32 s22, s22, s10
    s_xor_b32 s23, s23, s10
    s_or_b32 s16, s16, s17
    s_or_b32 s16, s16, s18
    s_or_b32 s16, s16, s19
    s_or_b32 s16, s16, s20
    s_or_b32 s16, s16, s21
    s_or_b32 s16, s16, s22
    s_or_b32 s16, s16, s23
    s_sub_u32 s71, s71, 1
    s_cbranch_scc1 L_sp1x
    s_cmp_lg_u32 s16, 0
    s_cbranch_scc1 L_sp1
L_sp1x:
L_q_mp:
    buffer_load_dwordx4 v[32:35], v14, s[52:55], s13 offen offset:0 sc1
    buffer_load_dwordx4 v[36:39], v14, s[52:55], s13 offen offset:1024 sc1
    buffer_load_dwordx4 v[40:43], v14, s[52:55], s13 offen offset:2048 sc1
    buffer_load_dwordx4 v[44:47], v14, s[52:55], s13 offen offset:3072 sc1
    buffer_load_dwordx2 v[48:49], v14, s[52:55], s13 offen offset:128 sc1
    buffer_load_dwordx2 v[50:51], v14, s[52:55], s13 offen offset:1152 sc1
    buffer_load_dwordx2 v[52:53], v14, s[52:55], s13 offen offset:2176 sc1
    buffer_load_dwordx2 v[54:55], v14, s[52:55], s13 offen offset:3200 sc1
    s_waitcnt vmcnt(0)
    v_cmp_ne_u32 vcc, v24, v35
    v_cmp_ne_u32 s[66:67], v24, v39
    s_or_b64 vcc, vcc, s[66:67]
    v_cmp_ne_u32 s[66:67], v24, v43
    s_or_b64 vcc, vcc, s[66:67]
    v_cmp_ne_u32 s[66:67], v24, v47
    s_or_b64 vcc, vcc, s[66:67]
    v_cmp_ne_u32 s[66:67], v24, v49
    s_or_b64 vcc, vcc, s[66:67]
    v_cmp_ne_u32 s[66:67], v24, v51
    s_or_b64 vcc, vcc, s[66:67]
    v_cmp_ne_u32 s[66:67], v24, v53
    s_or_b64 vcc, vcc, s[66:67]
    v_cmp_ne_u32 s[66:67], v24, v55
    s_or_b64 vcc, vcc, s[66:67]
    s_sub_u32 s70, s70, 1
    s_cbranch_scc1 L_bail
    s_cbranch_vccnz L_q_mp
    v_add_f32 v32, v32, v36
    v_add_f32 v33, v33, v37
    v_add_f32 v34, v34, v38
    v_add_f32 v35, v48, v50
    v_add_f32 v40, v40, v44
    v_add_f32 v41, v41, v45
    v_add_f32 v42, v42, v46
    v_add_f32 v43, v52, v54
    v_add_f32 v32, v32, v40
    v_add_f32 v33, v33, v41
    v_add_f32 v34, v34, v42
    v_add_f32 v35, v35, v43
    s_nop 0
    v_permlane32_swap_b32 v32, v34
    v_permlane32_swap_b32 v33, v35
    v_cvt_pk_bf16_f32 v20, v32, v33
    v_cvt_pk_bf16_f32 v21, v34, v35
    v_lshlrev_b32 v18, 16, v21
    v_and_b32 v19, 0xffff0000, v21
    v_lshlrev_b32 v16, 16, v20
    v_and_b32 v17, 0xffff0000, v20
    v_add_f32 v18, 1.0, v18
    v_add_f32 v19, 1.0, v19
    v_cvt_pk_bf16_f32 v21, v18, v19
    v_lshlrev_b32 v18, 16, v21
    v_and_b32 v19, 0xffff0000, v21
    v_mul_f32 v18, v18, v26
    v_mul_f32 v19, v19, v27
    v_cvt_pk_bf16_f32 v21, v18, v19
    v_lshlrev_b32 v18, 16, v21
    v_and_b32 v19, 0xffff0000, v21
    v_add_f32 v18, v18, v16
    v_add_f32 v19, v19, v17
    v_cvt_pk_bf16_f32 v21, v18, v19
    ds_write_b32 v11, v21
    ds_read_b128 v[32:35], v12
    ds_read_b128 v[36:39], v12 offset:64
    s_waitcnt lgkmcnt(1)
    v_mfma_f32_16x16x32_bf16 v[192:195], v[64:67], v[32:35], 0
    v_mfma_f32_16x16x32_bf16 v[196:199], v[68:71], v[32:35], 0
    v_mfma_f32_16x16x32_bf16 v[200:203], v[72:75], v[32:35], 0
    v_mfma_f32_16x16x32_bf16 v[204:207], v[76:79], v[32:35], 0
    v_mfma_f32_16x16x32_bf16 v[208:211], v[80:83], v[32:35], 0
    v_mfma_f32_16x16x32_bf16 v[212:215], v[84:87], v[32:35], 0
    v_mfma_f32_16x16x32_bf16 v[216:219], v[88:91], v[32:35], 0
    v_mfma_f32_16x16x32_bf16 v[220:223], v[92:95], v[32:35], 0
    s_waitcnt lgkmcnt(0)
    v_mfma_f32_16x16x32_bf16 v[192:195], v[96:99], v[36:39], v[192:195]
    v_mfma_f32_16x16x32_bf16 v[196:199], v[100:103], v[36:39], v[196:199]
    v_mfma_f32_16x16x32_bf16 v[200:203], v[104:107], v[36:39], v[200:203]
    v_mfma_f32_16x16x32_bf16 v[204:207], v[108:111], v[36:39], v[204:207]
    v_mfma_f32_16x16x32_bf16 v[208:211], v[112:115], v[36:39], v[208:211]
    v_mfma_f32_16x16x32_bf16 v[212:215], v[116:119], v[36:39], v[212:215]
    v_mfma_f32_16x16x32_bf16 v[216:219], v[120:123], v[36:39], v[216:219]
    v_mfma_f32_16x16x32_bf16 v[220:223], v[124:127], v[36:39], v[220:223]
    v_cmp_eq_u32 s[66:67], 1, v63
    v_cmp_eq_u32 vcc, 2, v63
    s_nop 0
    v_cndmask_b32 v192, v192, v196, s[66:67]
    v_cndmask_b32 v193, v193, v197, s[66:67]
    v_cndmask_b32 v194, v194, v198, s[66:67]
    v_cndmask_b32 v195, v195, v199, s[66:67]
    v_cmp_eq_u32 s[66:67], 3, v63
    v_cndmask_b32 v192, v192, v200, vcc
    v_cndmask_b32 v193, v193, v201, vcc
    v_cndmask_b32 v194, v194, v202, vcc
    v_cndmask_b32 v195, v195, v203, vcc
    v_cmp_eq_u32 vcc, 4, v63
    v_cndmask_b32 v192, v192, v204, s[66:67]
    v_cndmask_b32 v193, v193, v205, s[66:67]
    v_cndmask_b32 v194, v194, v206, s[66:67]
    v_cndmask_b32 v195, v195, v207, s[66:67]
    v_cmp_eq_u32 s[66:67], 5, v63
    v_cndmask_b32 v192, v192, v208, vcc
    v_cndmask_b32 v193, v193, v209, vcc
    v_cndmask_b32 v194, v194, v210, vcc
    v_cndmask_b32 v195, v195, v211, vcc
    v_cmp_eq_u32 vcc, 6, v63
    v_cndmask_b32 v192, v192, v212, s[66:67]
    v_cndmask_b32 v193, v193, v213, s[66:67]
    v_cndmask_b32 v194, v194, v214, s[66:67]
    v_cndmask_b32 v195, v195, v215, s[66:67]
    v_cmp_eq_u32 s[66:67], 7, v63
    v_cndmask_b32 v192, v192, v216, vcc
    v_cndmask_b32 v193, v193, v217, vcc
    v_cndmask_b32 v194, v194, v218, vcc
    v_cndmask_b32 v195, v195, v219, vcc
    v_cndmask_b32 v192, v192, v220, s[66:67]
    v_cndmask_b32 v193, v193, v221, s[66:67]
    v_cndmask_b32 v194, v194, v222, s[66:67]
    v_cndmask_b32 v195, v195, v223, s[66:67]
    v_mov_b32 v196, v195
    v_mov_b32 v195, s10
    v_mov_b32 v197, s10
    buffer_store_dwordx4 v[192:195], v13, s[52:55], s64 offen sc1
    buffer_store_dwordx2 v[196:197], v60, s[52:55], s92 offen sc1
    s_mov_b32 s70, 262144
    s_add_u32 s96, s42, s95
    s_addc_u32 s97, s43, 0
    s_mov_b32 s71, 64
L_sp2:
    s_load_dword s16, s[96:97], 780 glc
    s_load_dword s17, s[96:97], 1804 glc
    s_load_dword s18, s[96:97], 2828 glc
    s_load_dword s19, s[96:97], 3852 glc
    s_load_dword s20, s[96:97], 4876 glc
    s_load_dword s21, s[96:97], 5900 glc
    s_load_dword s22, s[96:97], 6924 glc
    s_load_dword s23, s[96:97], 7948 glc
    s_waitcnt lgkmcnt(0)
    s_xor_b32 s16, s16, s10
    s_xor_b32 s17, s17, s10
    s_xor_b32 s18, s18, s10
    s_xor_b32 s19, s19, s10
    s_xor_b32 s20, s20, s10
    s_xor_b32 s21, s21, s10
    s_xor_b32 s22, s22, s10
    s_xor_b32 s23, s23, s10
    s_or_b32 s16, s16, s17
    s_or_b32 s16, s16, s18
    s_or_b32 s16, s16, s19
    s_or_b32 s16, s16, s20
    s_or_b32 s16, s16, s21
    s_or_b32 s16, s16, s22
    s_or_b32 s16, s16, s23
    s_sub_u32 s71, s71, 1
    s_cbranch_scc1 L_sp2x
    s_cmp_lg_u32 s16, 0
    s_cbranch_scc1 L_sp2
L_sp2x:
L_q_qp:
    buffer_load_dwordx4 v[32:35], v6, s[52:55], s95 offen offset:0 sc1
    buffer_load_dwordx4 v[36:39], v6, s[52:55], s95 offen offset:2048 sc1
    buffer_load_dwordx4 v[40:43], v6, s[52:55], s65 offen offset:0 sc1
    buffer_load_dwordx4 v[44:47], v6, s[52:55], s65 offen offset:2048 sc1
    buffer_load_dwordx2 v[48:49], v61, s[52:55], s93 offen offset:0 sc1
    buffer_load_dwordx2 v[50:51], v61, s[52:55], s93 offen offset:1024 sc1
    buffer_load_dwordx2 v[52:53], v61, s[52:55], s93 offen offset:2048 sc1
    buffer_load_dwordx2 v[54:55], v61, s[52:55], s93 offen offset:3072 sc1
    s_waitcnt vmcnt(0)
    v_cmp_ne_u32 vcc, v24, v35
    v_cmp_ne_u32 s[66:67], v24, v39
    s_or_b64 vcc, vcc, s[66:67]
    v_cmp_ne_u32 s[66:67], v24, v43
    s_or_b64 vcc, vcc, s[66:67]
    v_cmp_ne_u32 s[66:67], v24, v47
    s_or_b64 vcc, vcc, s[66:67]
    v_cmp_ne_u32 s[66:67], v24, v49
    s_or_b64 vcc, vcc, s[66:67]
    v_cmp_ne_u32 s[66:67], v24, v51
    s_or_b64 vcc, vcc, s[66:67]
    v_cmp_ne_u32 s[66:67], v24, v53
    s_or_b64 vcc, vcc, s[66:67]
    v_cmp_ne_u32 s[66:67], v24, v55
    s_or_b64 vcc, vcc, s[66:67]
    s_sub_u32 s70, s70, 1
    s_cbranch_scc1 L_bail
    s_cbranch_vccnz L_q_qp
    v_add_f32 v32, v32, v36
    v_add_f32 v33, v33, v37
    v_add_f32 v34, v34, v38
    v_add_f32 v35, v48, v50
    v_add_f32 v40, v40, v44
    v_add_f32 v41, v41, v45
    v_add_f32 v42, v42, v46
    v_add_f32 v43, v52, v54
    v_add_f32 v32, v32, v40
    v_add_f32 v33, v33, v41
    v_add_f32 v34, v34, v42
    v_add_f32 v35, v35, v43
    s_nop 0
    v_permlane32_swap_b32 v32, v34
    v_permlane32_swap_b32 v33, v35
    v_add_f32 v32, v32, v34
    v_add_f32 v33, v33, v35
    v_cvt_pk_bf16_f32 v20, v32, v33
    ds_write_b32 v23, v20
L_s_bar1:
    s_waitcnt lgkmcnt(0)
    s_add_u32 s10, s11, 0x9e3779b9
    s_barrier
    s_barrier
    v_lshlrev_b32 v14, 2, v1
    v_and_b32 v14, 28, v14
    v_add_u32 v14, 148608, v14
    v_mov_b32 v15, s11
    ds_write_b32 v14, v15
L_dryret:
    s_cmp_lg_u32 s76, 4
    s_cbranch_scc1 L_s_wo
    s_cmp_lg_u32 s3, 6
    s_cbranch_scc1 L_s_wo
    v_lshlrev_b32 v14, 15, v3
    v_lshl_add_u32 v14, v4, 10, v14
    v_lshl_add_u32 v14, v5, 8, v14
    s_and_b32 s13, s77, 28
    s_lshl_b32 s13, s13, 10
    s_lshr_b32 s14, s77, 5
    s_lshl_b32 s14, s14, 6
    s_add_u32 s13, s13, s14
    s_and_b32 s14, s77, 3
    s_lshl_b32 s14, s14, 4
    s_add_u32 s13, s13, s14
    s_add_u32 s13, s13, 1441792
    v_lshlrev_b32 v15, 12, v3
    v_lshl_add_u32 v15, v5, 4, v15
    v_cmp_eq_u32 vcc, 0, v4
    s_nop 1
    v_cndmask_b32 v15, v31, v15, vcc
    s_lshl_b32 s14, s77, 6
    s_add_u32 s14, s14, 4096
    v_mov_b32 v24, s10
    s_mov_b32 s70, 262144
L_s_g4p:
    buffer_load_dwordx4 v[16:19], v14, s[52:55], s13 offen sc1
    buffer_load_dwordx2 v[20:21], v14, s[52:55], s13 offen offset:128 sc1
    s_waitcnt vmcnt(0)
    v_cmp_ne_u32 vcc, v24, v19
    v_cmp_ne_u32 s[66:67], v24, v21
    s_or_b64 vcc, vcc, s[66:67]
    s_sub_u32 s70, s70, 1
    s_cbranch_scc1 L_bail
    s_cbranch_vccz L_ok_16
    s_sleep 8
    s_branch L_s_g4p
L_ok_16:
    v_add_f32_dpp v16, v16, v16 row_ror:4 row_mask:0xf bank_mask:0xf
    v_add_f32_dpp v17, v17, v17 row_ror:4 row_mask:0xf bank_mask:0xf
    v_add_f32_dpp v18, v18, v18 row_ror:4 row_mask:0xf bank_mask:0xf
    v_add_f32_dpp v20, v20, v20 row_ror:4 row_mask:0xf bank_mask:0xf
    v_add_f32_dpp v16, v16, v16 row_ror:8 row_mask:0xf bank_mask:0xf
    v_add_f32_dpp v17, v17, v17 row_ror:8 row_mask:0xf bank_mask:0xf
    v_add_f32_dpp v18, v18, v18 row_ror:8 row_mask:0xf bank_mask:0xf
    v_add_f32_dpp v20, v20, v20 row_ror:8 row_mask:0xf bank_mask:0xf
    v_cvt_pk_bf16_f32 v16, v16, v17
    v_cvt_pk_bf16_f32 v17, v18, v20
    v_mov_b32 v18, s10
    v_mov_b32 v19, s10
    buffer_store_dwordx4 v[16:19], v15, s[52:55], s14 offen sc1
L_s_wo:
    s_load_dwordx2 s[24:25], s[0:1], 32
    v_lshlrev_b32 v14, 10, v3
    v_lshl_add_u32 v14, v2, 4, v14
    s_lshl_b32 s64, s6, 17
    s_lshl_b32 s13, s12, 8
    s_add_u32 s64, s64, s13
    v_lshlrev_b32 v30, 4, v3
    v_cmp_eq_u32 vcc, 0, v2
    s_nop 1
    v_cndmask_b32 v30, v31, v30, vcc
    s_lshl_b32 s74, s8, 18
    s_lshl_b32 s13, s12, 16
    s_add_u32 s74, s74, s13
    s_lshl_b32 s13, s6, 2
    s_add_u32 s13, s13, s9
    s_lshl_b32 s13, s13, 6
    s_add_u32 s74, s74, s13
    s_add_u32 s74, s74, 458752
    s_waitcnt vmcnt(0) lgkmcnt(0)
    s_mov_b32 s44, s24
    s_mov_b32 s45, s25
    s_mov_b32 s46, 0x400000
    s_mov_b32 s47, 0x20000
    buffer_load_dwordx4 v[64:67], v14, s[44:47], s64 offen
    s_addk_i32 s64, 0x1000
    buffer_load_dwordx4 v[68:71], v14, s[44:47], s64 offen
    s_addk_i32 s64, 0x1000
    buffer_load_dwordx4 v[72:75], v14, s[44:47], s64 offen
    s_addk_i32 s64, 0x1000
    s_waitcnt vmcnt(2)
    buffer_load_dwordx4 v[76:79], v14, s[44:47], s64 offen
    s_addk_i32 s64, 0x1000
    ds_write_b128 v7, v[64:67] offset:0
    s_waitcnt vmcnt(2)
    buffer_load_dwordx4 v[80:83], v14, s[44:47], s64 offen
    s_addk_i32 s64, 0x1000
    ds_write_b128 v7, v[68:71] offset:1024
    s_waitcnt vmcnt(2)
    buffer_load_dwordx4 v[84:87], v14, s[44:47], s64 offen
    s_addk_i32 s64, 0x1000
    ds_write_b128 v7, v[72:75] offset:2048
    s_waitcnt vmcnt(2)
    buffer_load_dwordx4 v[88:91], v14, s[44:47], s64 offen
    s_addk_i32 s64, 0x1000
    ds_write_b128 v7, v[76:79] offset:3072
    s_waitcnt vmcnt(2)
    buffer_load_dwordx4 v[92:95], v14, s[44:47], s64 offen
    s_addk_i32 s64, 0x1000
    ds_write_b128 v7, v[80:83] offset:4096
    s_waitcnt vmcnt(2)
    buffer_load_dwordx4 v[96:99], v14, s[44:47], s64 offen
    s_addk_i32 s64, 0x1000
    ds_write_b128 v7, v[84:87] offset:5120
    s_waitcnt vmcnt(2)
    buffer_load_dwordx4 v[100:103], v14, s[44:47], s64 offen
    s_addk_i32 s64, 0x1000
    ds_write_b128 v7, v[88:91] offset:6144
    s_waitcnt vmcnt(2)
    buffer_load_dwordx4 v[104:107], v14, s[44:47], s64 offen
    s_addk_i32 s64, 0x1000
    ds_write_b128 v7, v[92:95] offset:7168
    ds_read_b64_tr_b16 v[64:65], v8 offset:0
    ds_read_b64_tr_b16 v[66:67], v8 offset:1024
    ds_read_b64_tr_b16 v[68:69], v8 offset:32
    ds_read_b64_tr_b16 v[70:71], v8 offset:1056
    ds_read_b64_tr_b16 v[72:73], v8 offset:64
    ds_read_b64_tr_b16 v[74:75], v8 offset:1088
    ds_read_b64_tr_b16 v[76:77], v8 offset:96
    ds_read_b64_tr_b16 v[78:79], v8 offset:1120
    ds_read_b64_tr_b16 v[80:81], v8 offset:128
    ds_read_b64_tr_b16 v[82:83], v8 offset:1152
    ds_read_b64_tr_b16 v[84:85], v8 offset:160
    ds_read_b64_tr_b16 v[86:87], v8 offset:1184
    ds_read_b64_tr_b16 v[88:89], v8 offset:192
    ds_read_b64_tr_b16 v[90:91], v8 offset:1216
    ds_read_b64_tr_b16 v[92:93], v8 offset:224
    ds_read_b64_tr_b16 v[94:95], v8 offset:1248
    s_waitcnt vmcnt(2)
    buffer_load_dwordx4 v[108:111], v14, s[44:47], s64 offen
    s_addk_i32 s64, 0x1000
    ds_write_b128 v7, v[96:99] offset:0
    s_waitcnt vmcnt(2)
    buffer_load_dwordx4 v[112:115], v14, s[44:47], s64 offen
    s_addk_i32 s64, 0x1000
    ds_write_b128 v7, v[100:103] offset:1024
    s_waitcnt vmcnt(2)
    buffer_load_dwordx4 v[116:119], v14, s[44:47], s64 offen
    s_addk_i32 s64, 0x1000
    ds_write_b128 v7, v[104:107] offset:2048
    s_waitcnt vmcnt(2)
    buffer_load_dwordx4 v[120:123], v14, s[44:47], s64 offen
    s_addk_i32 s64, 0x1000
    ds_write_b128 v7, v[108:111] offset:3072
    s_waitcnt vmcnt(2)
    buffer_load_dwordx4 v[124:127], v14, s[44:47], s64 offen
    s_addk_i32 s64, 0x1000
    ds_write_b128 v7, v[112:115] offset:4096
    s_waitcnt vmcnt(2)
    buffer_load_dwordx4 v[128:131], v14, s[44:47], s64 offen
    s_addk_i32 s64, 0x1000
    ds_write_b128 v7, v[116:119] offset:5120
    s_waitcnt vmcnt(2)
    buffer_load_dwordx4 v[132:135], v14, s[44:47], s64 offen
    s_addk_i32 s64, 0x1000
    ds_write_b128 v7, v[120:123] offset:6144
    s_waitcnt vmcnt(2)
    buffer_load_dwordx4 v[136:139], v14, s[44:47], s64 offen
    s_addk_i32 s64, 0x1000
    ds_write_b128 v7, v[124:127] offset:7168
    ds_read_b64_tr_b16 v[96:97], v8 offset:0
    ds_read_b64_tr_b16 v[98:99], v8 offset:1024
    ds_read_b64_tr_b16 v[100:101], v8 offset:32
    ds_read_b64_tr_b16 v[102:103], v8 offset:1056
    ds_read_b64_tr_b16 v[104:105], v8 offset:64
    ds_read_b64_tr_b16 v[106:107], v8 offset:1088
    ds_read_b64_tr_b16 v[108:109], v8 offset:96
    ds_read_b64_tr_b16 v[110:111], v8 offset:1120
    ds_read_b64_tr_b16 v[112:113], v8 offset:128
    ds_read_b64_tr_b16 v[114:115], v8 offset:1152
    ds_read_b64_tr_b16 v[116:117], v8 offset:160
    ds_read_b64_tr_b16 v[118:119], v8 offset:1184
    ds_read_b64_tr_b16 v[120:121], v8 offset:192
    ds_read_b64_tr_b16 v[122:123], v8 offset:1216
    ds_read_b64_tr_b16 v[124:125], v8 offset:224
    ds_read_b64_tr_b16 v[126:127], v8 offset:1248
    s_waitcnt vmcnt(2)
    buffer_load_dwordx4 v[140:143], v14, s[44:47], s64 offen
    s_addk_i32 s64, 0x1000
    ds_write_b128 v7, v[128:131] offset:0
    s_waitcnt vmcnt(2)
    buffer_load_dwordx4 v[144:147], v14, s[44:47], s64 offen
    s_addk_i32 s64, 0x1000
    ds_write_b128 v7, v[132:135] offset:1024
    s_waitcnt vmcnt(2)
    buffer_load_dwordx4 v[148:151], v14, s[44:47], s64 offen
    s_addk_i32 s64, 0x1000
    ds_write_b128 v7, v[136:139] offset:2048
    s_waitcnt vmcnt(2)
    buffer_load_dwordx4 v[152:155], v14, s[44:47], s64 offen
    s_addk_i32 s64, 0x1000
    ds_write_b128 v7, v[140:143] offset:3072
    s_waitcnt vmcnt(2)
    buffer_load_dwordx4 v[156:159], v14, s[44:47], s64 offen
    s_addk_i32 s64, 0x1000
    ds_write_b128 v7, v[144:147] offset:4096
    s_waitcnt vmcnt(2)
    buffer_load_dwordx4 v[160:163], v14, s[44:47], s64 offen
    s_addk_i32 s64, 0x1000
    ds_write_b128 v7, v[148:151] offset:5120
    s_waitcnt vmcnt(2)
    buffer_load_dwordx4 v[164:167], v14, s[44:47], s64 offen
    s_addk_i32 s64, 0x1000
    ds_write_b128 v7, v[152:155] offset:6144
    s_waitcnt vmcnt(2)
    buffer_load_dwordx4 v[168:171], v14, s[44:47], s64 offen
    s_addk_i32 s64, 0x1000
    ds_write_b128 v7, v[156:159] offset:7168
    ds_read_b64_tr_b16 v[128:129], v8 offset:0
    ds_read_b64_tr_b16 v[130:131], v8 offset:1024
    ds_read_b64_tr_b16 v[132:133], v8 offset:32
    ds_read_b64_tr_b16 v[134:135], v8 offset:1056
    ds_read_b64_tr_b16 v[136:137], v8 offset:64
    ds_read_b64_tr_b16 v[138:139], v8 offset:1088
    ds_read_b64_tr_b16 v[140:141], v8 offset:96
    ds_read_b64_tr_b16 v[142:143], v8 offset:1120
    ds_read_b64_tr_b16 v[144:145], v8 offset:128
    ds_read_b64_tr_b16 v[146:147], v8 offset:1152
    ds_read_b64_tr_b16 v[148:149], v8 offset:160
    ds_read_b64_tr_b16 v[150:151], v8 offset:1184
    ds_read_b64_tr_b16 v[152:153], v8 offset:192
    ds_read_b64_tr_b16 v[154:155], v8 offset:1216
    ds_read_b64_tr_b16 v[156:157], v8 offset:224
    ds_read_b64_tr_b16 v[158:159], v8 offset:1248
    s_waitcnt vmcnt(2)
    buffer_load_dwordx4 v[172:175], v14, s[44:47], s64 offen
    s_addk_i32 s64, 0x1000
    ds_write_b128 v7, v[160:163] offset:0
    s_waitcnt vmcnt(2)
    buffer_load_dwordx4 v[176:179], v14, s[44:47], s64 offen
    s_addk_i32 s64, 0x1000
    ds_write_b128 v7, v[164:167] offset:1024
    s_waitcnt vmcnt(2)
    buffer_load_dwordx4 v[180:183], v14, s[44:47], s64 offen
    s_addk_i32 s64, 0x1000
    ds_write_b128 v7, v[168:171] offset:2048
    s_waitcnt vmcnt(2)
    buffer_load_dwordx4 v[184:187], v14, s[44:47], s64 offen
    s_addk_i32 s64, 0x1000
    ds_write_b128 v7, v[172:175] offset:3072
    s_waitcnt vmcnt(2)
    buffer_load_dwordx4 v[188:191], v14, s[44:47], s64 offen
    ds_write_b128 v7, v[176:179] offset:4096
    s_waitcnt vmcnt(2)
    ds_write_b128 v7, v[180:183] offset:5120
    s_waitcnt vmcnt(1)
    ds_write_b128 v7, v[184:187] offset:6144
    s_waitcnt vmcnt(0)
    ds_write_b128 v7, v[188:191] offset:7168
    ds_read_b64_tr_b16 v[160:161], v8 offset:0
    ds_read_b64_tr_b16 v[162:163], v8 offset:1024
    ds_read_b64_tr_b16 v[164:165], v8 offset:32
    ds_read_b64_tr_b16 v[166:167], v8 offset:1056
    ds_read_b64_tr_b16 v[168:169], v8 offset:64
    ds_read_b64_tr_b16 v[170:171], v8 offset:1088
    ds_read_b64_tr_b16 v[172:173], v8 offset:96
    ds_read_b64_tr_b16 v[174:175], v8 offset:1120
    ds_read_b64_tr_b16 v[176:177], v8 offset:128
    ds_read_b64_tr_b16 v[178:179], v8 offset:1152
    ds_read_b64_tr_b16 v[180:181], v8 offset:160
    ds_read_b64_tr_b16 v[182:183], v8 offset:1184
    ds_read_b64_tr_b16 v[184:185], v8 offset:192
    ds_read_b64_tr_b16 v[186:187], v8 offset:1216
    ds_read_b64_tr_b16 v[188:189], v8 offset:224
    ds_read_b64_tr_b16 v[190:191], v8 offset:1248
L_s_now:
    s_cmp_lg_u32 s76, 1
    s_cbranch_scc1 L_s_noffn
    s_load_dwordx4 s[28:31], s[0:1], 48
    s_mov_b32 s44, s32
    s_mov_b32 s45, s33
    s_mov_b32 s46, 0x158000
    s_mov_b32 s47, 0x20000
    s_lshl_b32 s64, s77, 15
    s_lshl_b32 s13, s12, 8
    s_add_u32 s64, s64, s13
    buffer_load_dwordx4 v[208:211], v14, s[44:47], s64 offen nt
    s_addk_i32 s64, 0x1000
    buffer_load_dwordx4 v[212:215], v14, s[44:47], s64 offen nt
    s_addk_i32 s64, 0x1000
    buffer_load_dwordx4 v[216:219], v14, s[44:47], s64 offen nt
    s_addk_i32 s64, 0x1000
    s_waitcnt vmcnt(2)
    buffer_load_dwordx4 v[220:223], v14, s[44:47], s64 offen nt
    s_addk_i32 s64, 0x1000
    s_waitcnt vmcnt(2)
    buffer_load_dwordx4 v[224:227], v14, s[44:47], s64 offen nt
    s_addk_i32 s64, 0x1000
    s_waitcnt vmcnt(2)
    buffer_load_dwordx4 v[228:231], v14, s[44:47], s64 offen nt
    s_addk_i32 s64, 0x1000
    s_waitcnt vmcnt(2)
    buffer_load_dwordx4 v[232:235], v14, s[44:47], s64 offen nt
    s_addk_i32 s64, 0x1000
    s_waitcnt vmcnt(2)
    buffer_load_dwordx4 v[236:239], v14, s[44:47], s64 offen nt
    s_addk_i32 s64, 0x1000
    v_lshrrev_b32 v9, 2, v1
    v_mul_u32_u24 v9, 2752, v9
    v_lshl_add_u32 v9, v5, 4, v9
    s_and_b32 s13, s12, 1
    s_mul_i32 s64, s13, 704512
    s_lshl_b32 s14, s77, 6
    s_add_u32 s64, s64, s14
    s_lshl_b32 s65, s12, 14
    s_add_u32 s65, s65, 32768
    s_waitcnt lgkmcnt(0)
    s_cmp_lt_u32 s12, 2
    s_cselect_b32 s44, s28, s30
    s_cselect_b32 s45, s29, s31
    s_mov_b32 s46, 0x158000
    s_waitcnt vmcnt(7)
    ds_write_b128 v7, v[208:211] offset:0
    s_waitcnt vmcnt(6)
    ds_write_b128 v7, v[212:215] offset:1024
    s_waitcnt vmcnt(5)
    ds_write_b128 v7, v[216:219] offset:2048
    s_waitcnt vmcnt(4)
    ds_write_b128 v7, v[220:223] offset:3072
    s_waitcnt vmcnt(3)
    ds_write_b128 v7, v[224:227] offset:4096
    s_waitcnt vmcnt(2)
    ds_write_b128 v7, v[228:231] offset:5120
    s_waitcnt vmcnt(1)
    ds_write_b128 v7, v[232:235] offset:6144
    s_waitcnt vmcnt(0)
    ds_write_b128 v7, v[236:239] offset:7168
    ds_read_b64_tr_b16 v[208:209], v8 offset:0
    ds_read_b64_tr_b16 v[210:211], v8 offset:1024
    ds_read_b64_tr_b16 v[212:213], v8 offset:32
    ds_read_b64_tr_b16 v[214:215], v8 offset:1056
    ds_read_b64_tr_b16 v[216:217], v8 offset:64
    ds_read_b64_tr_b16 v[218:219], v8 offset:1088
    ds_read_b64_tr_b16 v[220:221], v8 offset:96
    ds_read_b64_tr_b16 v[222:223], v8 offset:1120
    ds_read_b64_tr_b16 v[224:225], v8 offset:128
    ds_read_b64_tr_b16 v[226:227], v8 offset:1152
    ds_read_b64_tr_b16 v[228:229], v8 offset:160
    ds_read_b64_tr_b16 v[230:231], v8 offset:1184
    ds_read_b64_tr_b16 v[232:233], v8 offset:192
    ds_read_b64_tr_b16 v[234:235], v8 offset:1216
    ds_read_b64_tr_b16 v[236:237], v8 offset:224
    ds_read_b64_tr_b16 v[238:239], v8 offset:1248
    s_mov_b32 m0, s65
    s_nop 0
    buffer_load_dwordx4 v9, s[44:47], s64 offen  lds
    s_add_u32 s64, s64, 0xac00
    s_addk_i32 s65, 0x400
    s_mov_b32 m0, s65
    s_nop 0
    buffer_load_dwordx4 v9, s[44:47], s64 offen  lds
    s_add_u32 s64, s64, 0xac00
    s_addk_i32 s65, 0x400
    s_mov_b32 m0, s65
    s_nop 0
    buffer_load_dwordx4 v9, s[44:47], s64 offen  lds
    s_add_u32 s64, s64, 0xac00
    s_addk_i32 s65, 0x400
    s_waitcnt vmcnt(2)
    s_mov_b32 m0, s65
    s_nop 0
    buffer_load_dwordx4 v9, s[44:47], s64 offen  lds
    s_add_u32 s64, s64, 0xac00
    s_addk_i32 s65, 0x400
    s_waitcnt vmcnt(2)
    s_mov_b32 m0, s65
    s_nop 0
    buffer_load_dwordx4 v9, s[44:47], s64 offen  lds
    s_add_u32 s64, s64, 0xac00
    s_addk_i32 s65, 0x400
    s_waitcnt vmcnt(2)
    s_mov_b32 m0, s65
    s_nop 0
    buffer_load_dwordx4 v9, s[44:47], s64 offen  lds
    s_add_u32 s64, s64, 0xac00
    s_addk_i32 s65, 0x400
    s_waitcnt vmcnt(2)
    s_mov_b32 m0, s65
    s_nop 0
    buffer_load_dwordx4 v9, s[44:47], s64 offen  lds
    s_add_u32 s64, s64, 0xac00
    s_addk_i32 s65, 0x400
    s_waitcnt vmcnt(2)
    s_mov_b32 m0, s65
    s_nop 0
    buffer_load_dwordx4 v9, s[44:47], s64 offen  lds
    s_add_u32 s64, s64, 0xac00
    s_addk_i32 s65, 0x400
    s_waitcnt vmcnt(2)
    s_mov_b32 m0, s65
    s_nop 0
    buffer_load_dwordx4 v9, s[44:47], s64 offen  lds
    s_add_u32 s64, s64, 0xac00
    s_addk_i32 s65, 0x400
    s_waitcnt vmcnt(2)
    s_mov_b32 m0, s65
    s_nop 0
    buffer_load_dwordx4 v9, s[44:47], s64 offen  lds
    s_add_u32 s64, s64, 0xac00
    s_addk_i32 s65, 0x400
    s_waitcnt vmcnt(2)
    s_mov_b32 m0, s65
    s_nop 0
    buffer_load_dwordx4 v9, s[44:47], s64 offen  lds
    s_add_u32 s64, s64, 0xac00
    s_addk_i32 s65, 0x400
    s_waitcnt vmcnt(2)
    s_mov_b32 m0, s65
    s_nop 0
    buffer_load_dwordx4 v9, s[44:47], s64 offen  lds
    s_add_u32 s64, s64, 0xac00
    s_addk_i32 s65, 0x400
    s_waitcnt vmcnt(2)
    s_mov_b32 m0, s65
    s_nop 0
    buffer_load_dwordx4 v9, s[44:47], s64 offen  lds
    s_add_u32 s64, s64, 0xac00
    s_addk_i32 s65, 0x400
    s_waitcnt vmcnt(2)
    s_mov_b32 m0, s65
    s_nop 0
    buffer_load_dwordx4 v9, s[44:47], s64 offen  lds
    s_add_u32 s64, s64, 0xac00
    s_addk_i32 s65, 0x400
    s_waitcnt vmcnt(2)
    s_mov_b32 m0, s65
    s_nop 0
    buffer_load_dwordx4 v9, s[44:47], s64 offen  lds
    s_add_u32 s64, s64, 0xac00
    s_addk_i32 s65, 0x400
    s_waitcnt vmcnt(2)
    s_mov_b32 m0, s65
    s_nop 0
    buffer_load_dwordx4 v9, s[44:47], s64 offen  lds
    s_add_u32 s64, s64, 0xac00
    s_addk_i32 s65, 0x400
L_s_noffn:
    v_mul_u32_u24 v15, 272, v5
    v_lshl_add_u32 v15, v3, 4, v15
    v_add_u32 v15, 148640, v15
    v_and_b32 v10, 1, v1
    v_lshlrev_b32 v29, 4, v3
    s_mov_b32 s13, 98304
    v_mul_lo_u32 v11, v10, s13
    v_add_u32 v29, v29, v11
    v_cmp_gt_u32 vcc, 2, v2
    s_nop 1
    v_cndmask_b32 v29, v31, v29, vcc
    s_mul_i32 s75, s12, 24576
    s_lshl_b32 s13, s77, 6
    s_add_u32 s75, s75, s13
    s_add_u32 s75, s75, 983040
    v_lshlrev_b32 v28, 6, v10
    v_lshl_add_u32 v28, v3, 4, v28
    v_add_u32 v28, 148480, v28
    v_mov_b32 v20, 148608
    v_mov_b32 v21, s10
    v_mov_b32 v22, 0xffffff00
    s_lshr_b32 s92, s10, 8
    s_lshr_b32 s93, s10, 16
    s_lshr_b32 s94, s10, 24
    s_waitcnt vmcnt(0) lgkmcnt(0)
    s_mov_b32 s98, 1048576
    s_mov_b32 s70, 1048576
    s_barrier
L_stepA:
    ds_read_b128 v[192:195], v15 offset:0
    ds_read_b128 v[196:199], v15 offset:64
    ds_read_b128 v[200:203], v15 offset:128
    ds_read_b128 v[204:207], v15 offset:192
    s_waitcnt lgkmcnt(3)
    v_mfma_f32_16x16x32_bf16 v[32:35], v[64:67], v[192:195], 0
    s_waitcnt lgkmcnt(2)
    v_mfma_f32_16x16x32_bf16 v[32:35], v[96:99], v[196:199], v[32:35]
    s_waitcnt lgkmcnt(1)
    v_mfma_f32_16x16x32_bf16 v[32:35], v[128:131], v[200:203], v[32:35]
    s_waitcnt lgkmcnt(0)
    v_mfma_f32_16x16x32_bf16 v[32:35], v[160:163], v[204:207], v[32:35]
    v_mfma_f32_16x16x32_bf16 v[36:39], v[68:71], v[192:195], 0
    v_mfma_f32_16x16x32_bf16 v[36:39], v[100:103], v[196:199], v[36:39]
    v_mfma_f32_16x16x32_bf16 v[36:39], v[132:135], v[200:203], v[36:39]
    v_mfma_f32_16x16x32_bf16 v[36:39], v[164:167], v[204:207], v[36:39]
    v_mfma_f32_16x16x32_bf16 v[40:43], v[72:75], v[192:195], 0
    s_nop 2
    v_add_f32_dpp v32, v32, v32 quad_perm:[1,0,3,2] row_mask:0xf bank_mask:0xf
    v_add_f32_dpp v33, v33, v33 quad_perm:[1,0,3,2] row_mask:0xf bank_mask:0xf
    v_add_f32_dpp v34, v34, v34 quad_perm:[1,0,3,2] row_mask:0xf bank_mask:0xf
    v_mfma_f32_16x16x32_bf16 v[40:43], v[104:107], v[196:199], v[40:43]
    v_add_f32_dpp v35, v35, v35 quad_perm:[1,0,3,2] row_mask:0xf bank_mask:0xf
    v_add_f32_dpp v32, v32, v32 quad_perm:[2,3,0,1] row_mask:0xf bank_mask:0xf
    v_add_f32_dpp v33, v33, v33 quad_perm:[2,3,0,1] row_mask:0xf bank_mask:0xf
    v_mfma_f32_16x16x32_bf16 v[40:43], v[136:139], v[200:203], v[40:43]
    v_add_f32_dpp v34, v34, v34 quad_perm:[2,3,0,1] row_mask:0xf bank_mask:0xf
    v_add_f32_dpp v35, v35, v35 quad_perm:[2,3,0,1] row_mask:0xf bank_mask:0xf
    v_bfi_b32 v32, v22, v32, s10
    v_mfma_f32_16x16x32_bf16 v[40:43], v[168:171], v[204:207], v[40:43]
    v_bfi_b32 v33, v22, v33, s92
    v_bfi_b32 v34, v22, v34, s93
    v_bfi_b32 v35, v22, v35, s94
    buffer_store_dwordx4 v[32:35], v30, s[52:55], s74 offen sc1
    s_addk_i32 s74, 0x2000
    v_mfma_f32_16x16x32_bf16 v[44:47], v[76:79], v[192:195], 0
    v_add_f32_dpp v36, v36, v36 quad_perm:[1,0,3,2] row_mask:0xf bank_mask:0xf
    v_add_f32_dpp v37, v37, v37 quad_perm:[1,0,3,2] row_mask:0xf bank_mask:0xf
    v_add_f32_dpp v38, v38, v38 quad_perm:[1,0,3,2] row_mask:0xf bank_mask:0xf
    v_mfma_f32_16x16x32_bf16 v[44:47], v[108:111], v[196:199], v[44:47]
    v_add_f32_dpp v39, v39, v39 quad_perm:[1,0,3,2] row_mask:0xf bank_mask:0xf
    v_add_f32_dpp v36, v36, v36 quad_perm:[2,3,0,1] row_mask:0xf bank_mask:0xf
    v_add_f32_dpp v37, v37, v37 quad_perm:[2,3,0,1] row_mask:0xf bank_mask:0xf
    v_mfma_f32_16x16x32_bf16 v[44:47], v[140:143], v[200:203], v[44:47]
    v_add_f32_dpp v38, v38, v38 quad_perm:[2,3,0,1] row_mask:0xf bank_mask:0xf
    v_add_f32_dpp v39, v39, v39 quad_perm:[2,3,0,1] row_mask:0xf bank_mask:0xf
    v_bfi_b32 v36, v22, v36, s10
    v_mfma_f32_16x16x32_bf16 v[44:47], v[172:175], v[204:207], v[44:47]
    v_bfi_b32 v37, v22, v37, s92
    v_bfi_b32 v38, v22, v38, s93
    v_bfi_b32 v39, v22, v39, s94
    buffer_store_dwordx4 v[36:39], v30, s[52:55], s74 offen sc1
    s_addk_i32 s74, 0x2000
    v_mfma_f32_16x16x32_bf16 v[48:51], v[80:83], v[192:195], 0
    v_add_f32_dpp v40, v40, v40 quad_perm:[1,0,3,2] row_mask:0xf bank_mask:0xf
    v_add_f32_dpp v41, v41, v41 quad_perm:[1,0,3,2] row_mask:0xf bank_mask:0xf
    v_add_f32_dpp v42, v42, v42 quad_perm:[1,0,3,2] row_mask:0xf bank_mask:0xf
    v_mfma_f32_16x16x32_bf16 v[48:51], v[112:115], v[196:199], v[48:51]
    v_add_f32_dpp v43, v43, v43 quad_perm:[1,0,3,2] row_mask:0xf bank_mask:0xf
    v_add_f32_dpp v40, v40, v40 quad_perm:[2,3,0,1] row_mask:0xf bank_mask:0xf
    v_add_f32_dpp v41, v41, v41 quad_perm:[2,3,0,1] row_mask:0xf bank_mask:0xf
    v_mfma_f32_16x16x32_bf16 v[48:51], v[144:147], v[200:203], v[48:51]
    v_add_f32_dpp v42, v42, v42 quad_perm:[2,3,0,1] row_mask:0xf bank_mask:0xf
    v_add_f32_dpp v43, v43, v43 quad_perm:[2,3,0,1] row_mask:0xf bank_mask:0xf
    v_bfi_b32 v40, v22, v40, s10
    v_mfma_f32_16x16x32_bf16 v[48:51], v[176:179], v[204:207], v[48:51]
    v_bfi_b32 v41, v22, v41, s92
    v_bfi_b32 v42, v22, v42, s93
    v_bfi_b32 v43, v22, v43, s94
    buffer_store_dwordx4 v[40:43], v30, s[52:55], s74 offen sc1
    s_addk_i32 s74, 0x2000
    v_mfma_f32_16x16x32_bf16 v[52:55], v[84:87], v[192:195], 0
    v_add_f32_dpp v44, v44, v44 quad_perm:[1,0,3,2] row_mask:0xf bank_mask:0xf
    v_add_f32_dpp v45, v45, v45 quad_perm:[1,0,3,2] row_mask:0xf bank_mask:0xf
    v_add_f32_dpp v46, v46, v46 quad_perm:[1,0,3,2] row_mask:0xf bank_mask:0xf
    v_mfma_f32_16x16x32_bf16 v[52:55], v[116:119], v[196:199], v[52:55]
    v_add_f32_dpp v47, v47, v47 quad_perm:[1,0,3,2] row_mask:0xf bank_mask:0xf
    v_add_f32_dpp v44, v44, v44 quad_perm:[2,3,0,1] row_mask:0xf bank_mask:0xf
    v_add_f32_dpp v45, v45, v45 quad_perm:[2,3,0,1] row_mask:0xf bank_mask:0xf
    v_mfma_f32_16x16x32_bf16 v[52:55], v[148:151], v[200:203], v[52:55]
    v_add_f32_dpp v46, v46, v46 quad_perm:[2,3,0,1] row_mask:0xf bank_mask:0xf
    v_add_f32_dpp v47, v47, v47 quad_perm:[2,3,0,1] row_mask:0xf bank_mask:0xf
    v_bfi_b32 v44, v22, v44, s10
    v_mfma_f32_16x16x32_bf16 v[52:55], v[180:183], v[204:207], v[52:55]
    v_bfi_b32 v45, v22, v45, s92
    v_bfi_b32 v46, v22, v46, s93
    v_bfi_b32 v47, v22, v47, s94
    buffer_store_dwordx4 v[44:47], v30, s[52:55], s74 offen sc1
    s_addk_i32 s74, 0x2000
    v_mfma_f32_16x16x32_bf16 v[56:59], v[88:91], v[192:195], 0
    v_add_f32_dpp v48, v48, v48 quad_perm:[1,0,3,2] row_mask:0xf bank_mask:0xf
    v_add_f32_dpp v49, v49, v49 quad_perm:[1,0,3,2] row_mask:0xf bank_mask:0xf
    v_add_f32_dpp v50, v50, v50 quad_perm:[1,0,3,2] row_mask:0xf bank_mask:0xf
    v_mfma_f32_16x16x32_bf16 v[56:59], v[120:123], v[196:199], v[56:59]
    v_add_f32_dpp v51, v51, v51 quad_perm:[1,0,3,2] row_mask:0xf bank_mask:0xf
    v_add_f32_dpp v48, v48, v48 quad_perm:[2,3,0,1] row_mask:0xf bank_mask:0xf
    v_add_f32_dpp v49, v49, v49 quad_perm:[2,3,0,1] row_mask:0xf bank_mask:0xf
    v_mfma_f32_16x16x32_bf16 v[56:59], v[152:155], v[200:203], v[56:59]
    v_add_f32_dpp v50, v50, v50 quad_perm:[2,3,0,1] row_mask:0xf bank_mask:0xf
    v_add_f32_dpp v51, v51, v51 quad_perm:[2,3,0,1] row_mask:0xf bank_mask:0xf
    v_bfi_b32 v48, v22, v48, s10
    v_mfma_f32_16x16x32_bf16 v[56:59], v[184:187], v[204:207], v[56:59]
    v_bfi_b32 v49, v22, v49, s92
    v_bfi_b32 v50, v22, v50, s93
    v_bfi_b32 v51, v22, v51, s94
    buffer_store_dwordx4 v[48:51], v30, s[52:55], s74 offen sc1
    s_addk_i32 s74, 0x2000
    v_mfma_f32_16x16x32_bf16 v[60:63], v[92:95], v[192:195], 0
    v_add_f32_dpp v52, v52, v52 quad_perm:[1,0,3,2] row_mask:0xf bank_mask:0xf
    v_add_f32_dpp v53, v53, v53 quad_perm:[1,0,3,2] row_mask:0xf bank_mask:0xf
    v_add_f32_dpp v54, v54, v54 quad_perm:[1,0,3,2] row_mask:0xf bank_mask:0xf
    v_mfma_f32_16x16x32_bf16 v[60:63], v[124:127], v[196:199], v[60:63]
    v_add_f32_dpp v55, v55, v55 quad_perm:[1,0,3,2] row_mask:0xf bank_mask:0xf
    v_add_f32_dpp v52, v52, v52 quad_perm:[2,3,0,1] row_mask:0xf bank_mask:0xf
    v_add_f32_dpp v53, v53, v53 quad_perm:[2,3,0,1] row_mask:0xf bank_mask:0xf
    v_mfma_f32_16x16x32_bf16 v[60:63], v[156:159], v[200:203], v[60:63]
    v_add_f32_dpp v54, v54, v54 quad_perm:[2,3,0,1] row_mask:0xf bank_mask:0xf
    v_add_f32_dpp v55, v55, v55 quad_perm:[2,3,0,1] row_mask:0xf bank_mask:0xf
    v_bfi_b32 v52, v22, v52, s10
    v_mfma_f32_16x16x32_bf16 v[60:63], v[188:191], v[204:207], v[60:63]
    v_bfi_b32 v53, v22, v53, s92
    v_bfi_b32 v54, v22, v54, s93
    v_bfi_b32 v55, v22, v55, s94
    buffer_store_dwordx4 v[52:55], v30, s[52:55], s74 offen sc1
    s_addk_i32 s74, 0x2000
    v_add_f32_dpp v56, v56, v56 quad_perm:[1,0,3,2] row_mask:0xf bank_mask:0xf
    v_add_f32_dpp v57, v57, v57 quad_perm:[1,0,3,2] row_mask:0xf bank_mask:0xf
    v_add_f32_dpp v58, v58, v58 quad_perm:[1,0,3,2] row_mask:0xf bank_mask:0xf
    v_add_f32_dpp v59, v59, v59 quad_perm:[1,0,3,2] row_mask:0xf bank_mask:0xf
    v_add_f32_dpp v56, v56, v56 quad_perm:[2,3,0,1] row_mask:0xf bank_mask:0xf
    v_add_f32_dpp v57, v57, v57 quad_perm:[2,3,0,1] row_mask:0xf bank_mask:0xf
    v_add_f32_dpp v58, v58, v58 quad_perm:[2,3,0,1] row_mask:0xf bank_mask:0xf
    v_add_f32_dpp v59, v59, v59 quad_perm:[2,3,0,1] row_mask:0xf bank_mask:0xf
    v_bfi_b32 v56, v22, v56, s10
    v_bfi_b32 v57, v22, v57, s92
    v_bfi_b32 v58, v22, v58, s93
    v_bfi_b32 v59, v22, v59, s94
    buffer_store_dwordx4 v[56:59], v30, s[52:55], s74 offen sc1
    s_addk_i32 s74, 0x2000
    v_add_f32_dpp v60, v60, v60 quad_perm:[1,0,3,2] row_mask:0xf bank_mask:0xf
    v_add_f32_dpp v61, v61, v61 quad_perm:[1,0,3,2] row_mask:0xf bank_mask:0xf
    v_add_f32_dpp v62, v62, v62 quad_perm:[1,0,3,2] row_mask:0xf bank_mask:0xf
    v_add_f32_dpp v63, v63, v63 quad_perm:[1,0,3,2] row_mask:0xf bank_mask:0xf
    v_add_f32_dpp v60, v60, v60 quad_perm:[2,3,0,1] row_mask:0xf bank_mask:0xf
    v_add_f32_dpp v61, v61, v61 quad_perm:[2,3,0,1] row_mask:0xf bank_mask:0xf
    v_add_f32_dpp v62, v62, v62 quad_perm:[2,3,0,1] row_mask:0xf bank_mask:0xf
    v_add_f32_dpp v63, v63, v63 quad_perm:[2,3,0,1] row_mask:0xf bank_mask:0xf
    v_bfi_b32 v60, v22, v60, s10
    v_bfi_b32 v61, v22, v61, s92
    v_bfi_b32 v62, v22, v62, s93
    v_bfi_b32 v63, v22, v63, s94
    buffer_store_dwordx4 v[60:63], v30, s[52:55], s74 offen sc1
    s_cmp_lg_u32 s76, 1
    s_cbranch_scc1 L_fin2
L_f2:
    ds_read_b128 v[24:27], v20 offset:16
    ds_read_b128 v[16:19], v28
    s_waitcnt lgkmcnt(0)
    v_cmp_ne_u32 vcc, v21, v24
    v_cmp_ne_u32 s[66:67], v21, v25
    s_or_b64 vcc, vcc, s[66:67]
    v_cmp_ne_u32 s[66:67], v21, v26
    s_or_b64 vcc, vcc, s[66:67]
    v_cmp_ne_u32 s[66:67], v21, v27
    s_or_b64 vcc, vcc, s[66:67]
    s_sub_u32 s70, s70, 1
    s_cbranch_scc1 L_to_18
    s_cbranch_vccnz L_f2
L_out_17:
    v_mfma_f32_16x16x32_bf16 v[32:35], v[208:211], v[16:19], 0
    v_mfma_f32_16x16x32_bf16 v[36:39], v[212:215], v[16:19], 0
    v_mfma_f32_16x16x32_bf16 v[40:43], v[216:219], v[16:19], 0
    s_nop 5
    v_bfi_b32 v32, v22, v32, s10
    v_bfi_b32 v33, v22, v33, s92
    v_bfi_b32 v34, v22, v34, s93
    v_bfi_b32 v35, v22, v35, s94
    buffer_store_dwordx4 v[32:35], v29, s[52:55], s75 offen sc1
    s_addk_i32 s75, 0xc00
    v_mfma_f32_16x16x32_bf16 v[44:47], v[220:223], v[16:19], 0
    v_bfi_b32 v36, v22, v36, s10
    v_bfi_b32 v37, v22, v37, s92
    v_bfi_b32 v38, v22, v38, s93
    v_bfi_b32 v39, v22, v39, s94
    buffer_store_dwordx4 v[36:39], v29, s[52:55], s75 offen sc1
    s_addk_i32 s75, 0xc00
    v_mfma_f32_16x16x32_bf16 v[48:51], v[224:227], v[16:19], 0
    v_bfi_b32 v40, v22, v40, s10
    v_bfi_b32 v41, v22, v41, s92
    v_bfi_b32 v42, v22, v42, s93
    v_bfi_b32 v43, v22, v43, s94
    buffer_store_dwordx4 v[40:43], v29, s[52:55], s75 offen sc1
    s_addk_i32 s75, 0xc00
    v_mfma_f32_16x16x32_bf16 v[52:55], v[228:231], v[16:19], 0
    v_bfi_b32 v44, v22, v44, s10
    v_bfi_b32 v45, v22, v45, s92
    v_bfi_b32 v46, v22, v46, s93
    v_bfi_b32 v47, v22, v47, s94
    buffer_store_dwordx4 v[44:47], v29, s[52:55], s75 offen sc1
    s_addk_i32 s75, 0xc00
    v_mfma_f32_16x16x32_bf16 v[56:59], v[232:235], v[16:19], 0
    v_bfi_b32 v48, v22, v48, s10
    v_bfi_b32 v49, v22, v49, s92
    v_bfi_b32 v50, v22, v50, s93
    v_bfi_b32 v51, v22, v51, s94
    buffer_store_dwordx4 v[48:51], v29, s[52:55], s75 offen sc1
    s_addk_i32 s75, 0xc00
    v_mfma_f32_16x16x32_bf16 v[60:63], v[236:239], v[16:19], 0
    v_bfi_b32 v52, v22, v52, s10
    v_bfi_b32 v53, v22, v53, s92
    v_bfi_b32 v54, v22, v54, s93
    v_bfi_b32 v55, v22, v55, s94
    buffer_store_dwordx4 v[52:55], v29, s[52:55], s75 offen sc1
    s_addk_i32 s75, 0xc00
    v_bfi_b32 v56, v22, v56, s10
    v_bfi_b32 v57, v22, v57, s92
    v_bfi_b32 v58, v22, v58, s93
    v_bfi_b32 v59, v22, v59, s94
    buffer_store_dwordx4 v[56:59], v29, s[52:55], s75 offen sc1
    s_addk_i32 s75, 0xc00
    v_bfi_b32 v60, v22, v60, s10
    v_bfi_b32 v61, v22, v61, s92
    v_bfi_b32 v62, v22, v62, s93
    v_bfi_b32 v63, v22, v63, s94
    buffer_store_dwordx4 v[60:63], v29, s[52:55], s75 offen sc1
    s_addk_i32 s75, 0xc00
L_fin2:
    s_endpgm
L_to_3:
    s_cmp_eq_u32 s98, 0
    s_cbranch_scc1 L_out_2
    s_endpgm
L_to_5:
    s_cmp_eq_u32 s98, 0
    s_cbranch_scc1 L_out_4
    s_endpgm
L_to_7:
    s_cmp_eq_u32 s98, 0
    s_cbranch_scc1 L_out_6
    s_endpgm
L_to_9:
    s_cmp_eq_u32 s98, 0
    s_cbranch_scc1 L_out_8
    s_endpgm
L_to_12:
    s_cmp_eq_u32 s98, 0
    s_cbranch_scc1 L_out_11
    s_endpgm
L_to_14:
    s_cmp_eq_u32 s98, 0
    s_cbranch_scc1 L_out_13
    s_endpgm
L_to_18:
    s_cmp_eq_u32 s98, 0
    s_cbranch_scc1 L_out_17
    s_endpgm
L_mlx:
    s_cmp_eq_u32 s12, 0
    s_cbranch_scc1 L_ml0
    s_sub_u32 s14, s12, 1
    s_lshl_b32 s14, s14, 7
    s_add_u32 s94, s96, s14
    s_addc_u32 s95, s97, 0
    s_branch L_fchk
L_fpoll:
    s_load_dwordx16 s[16:31], s[94:95], 0 glc
    s_load_dwordx8 s[32:39], s[94:95], 64 glc
    s_load_dwordx8 s[56:63], s[94:95], 96 glc
L_fchk:
    s_waitcnt lgkmcnt(0)
    s_mov_b32 s15, 0
    s_xor_b32 s14, s17, s10
    s_or_b32 s15, s15, s14
    s_xor_b32 s14, s19, s10
    s_or_b32 s15, s15, s14
    s_xor_b32 s14, s21, s10
    s_or_b32 s15, s15, s14
    s_xor_b32 s14, s23, s10
    s_or_b32 s15, s15, s14
    s_xor_b32 s14, s25, s10
    s_or_b32 s15, s15, s14
    s_xor_b32 s14, s27, s10
    s_or_b32 s15, s15, s14
    s_xor_b32 s14, s29, s10
    s_or_b32 s15, s15, s14
    s_xor_b32 s14, s31, s10
    s_or_b32 s15, s15, s14
    s_xor_b32 s14, s33, s10
    s_or_b32 s15, s15, s14
    s_xor_b32 s14, s35, s10
    s_or_b32 s15, s15, s14
    s_xor_b32 s14, s37, s10
    s_or_b32 s15, s15, s14
    s_xor_b32 s14, s39, s10
    s_or_b32 s15, s15, s14
    s_xor_b32 s14, s57, s10
    s_or_b32 s15, s15, s14
    s_xor_b32 s14, s59, s10
    s_or_b32 s15, s15, s14
    s_xor_b32 s14, s61, s10
    s_or_b32 s15, s15, s14
    s_xor_b32 s14, s63, s10
    s_or_b32 s15, s15, s14
    s_sub_u32 s70, s70, 1
    s_cbranch_scc1 L_bail
    s_cmp_lg_u32 s15, 0
    s_cbranch_scc1 L_fpoll
    v_mov_b32 v29, v30
    v_max_f32 v30, s16, v30
    v_max_f32 v30, s20, v30
    v_max_f32 v30, s24, v30
    v_max_f32 v30, s28, v30
    v_max_f32 v30, s32, v30
    v_max_f32 v30, s36, v30
    v_max_f32 v30, s56, v30
    v_max_f32 v30, s60, v30
    v_sub_f32 v29, v29, v30
    v_sub_f32 v16, s16, v30
    v_sub_f32 v17, s20, v30
    v_sub_f32 v18, s24, v30
    v_sub_f32 v19, s28, v30
    v_sub_f32 v20, s32, v30
    v_sub_f32 v21, s36, v30
    v_sub_f32 v22, s56, v30
    v_sub_f32 v23, s60, v30
    v_mul_f32 v29, s13, v29
    v_mul_f32 v16, s13, v16
    v_mul_f32 v17, s13, v17
    v_mul_f32 v18, s13, v18
    v_mul_f32 v19, s13, v19
    v_mul_f32 v20, s13, v20
    v_mul_f32 v21, s13, v21
    v_mul_f32 v22, s13, v22
    v_mul_f32 v23, s13, v23
    v_exp_f32 v29, v29
    v_exp_f32 v16, v16
    v_exp_f32 v17, v17
    v_exp_f32 v18, v18
    v_exp_f32 v19, v19
    v_exp_f32 v20, v20
    v_exp_f32 v21, v21
    v_exp_f32 v22, v22
    v_exp_f32 v23, v23
    v_mul_f32 v31, v31, v29
    v_fmac_f32 v31, s18, v16
    v_fmac_f32 v31, s22, v17
    v_fmac_f32 v31, s26, v18
    v_fmac_f32 v31, s30, v19
    v_fmac_f32 v31, s34, v20
    v_fmac_f32 v31, s38, v21
    v_fmac_f32 v31, s58, v22
    v_fmac_f32 v31, s62, v23
    s_cmp_eq_u32 s12, 2
    s_cbranch_scc1 L_ml2
    s_load_dwordx16 s[16:31], s[96:97], 128 glc
    s_load_dwordx8 s[32:39], s[96:97], 192 glc
    s_load_dwordx8 s[56:63], s[96:97], 224 glc
    s_branch L_vloop
L_ml0:
    s_load_dwordx16 s[16:31], s[96:97], 0 glc
    s_load_dwordx8 s[32:39], s[96:97], 64 glc
    s_load_dwordx8 s[56:63], s[96:97], 96 glc
    s_branch L_vloop
L_ml2:
    v_sub_f32 v30, s73, v30
    v_rcp_f32 v31, v31
    v_mul_f32 v30, s13, v30
    v_exp_f32 v30, v30
    s_nop 0
    v_mul_f32 v30, v30, v31
    s_branch L_vloop2
L_bail:
    s_endpgm
L_codeend:
.section .rodata,"a"
.p2align 6
.amdhsa_kernel adaLN_cond__mha_block_cached__glu_gated_swiglu__decode_kernel
  .amdhsa_next_free_vgpr 256
  .amdhsa_next_free_sgpr 102
  .amdhsa_accum_offset 256
  .amdhsa_group_segment_fixed_size 0
  .amdhsa_kernarg_size 112
  .amdhsa_user_sgpr_count 2
  .amdhsa_user_sgpr_kernarg_segment_ptr 1
  .amdhsa_system_sgpr_workgroup_id_x 1
  .amdhsa_float_denorm_mode_32 3
.end_amdhsa_kernel
```
